```python
import torch

def _softmax(x, axis=-1):
    return torch.softmax(x, dim=axis)
def _gelu(x):
    return torch.nn.functional.gelu(x, approximate="tanh")
def _silu(x):
    return torch.nn.functional.silu(x)
def _sigmoid(x):
    return torch.sigmoid(x)
def _layernorm(x, axis=-1, eps=1e-5):
    m = x.mean(dim=axis, keepdim=True)
    v = x.var(dim=axis, keepdim=True, unbiased=False)
    return (x - m) / torch.sqrt(v + eps)
def _scatter_add(tgt, idx, src, axis=0):
    return tgt.clone().index_add_(axis, idx, src)
def _segment_sum(src, seg, n):
    out = torch.zeros((n,) + src.shape[1:], dtype=src.dtype)
    return out.index_add_(0, seg, src)
def _pad(x, pw):
    flat = tuple(v for pair in reversed(pw) for v in pair)
    return torch.nn.functional.pad(x, flat)

kernel_name = 'gated_mix__sliding_block_cached__gqa_block_cached__decode'

def setup_inputs():

    _w = (lambda a: (lambda t: t.to(torch.bfloat16) if t.is_floating_point() else t)(torch.as_tensor(a)))
    def _A_setup():
        B, Sq, D = 1, 1, 448
        Hq, Hkv, Sk, Dh = 16, 8, 8192, 256
        assert Hq % Hkv == 0, (Hq, Hkv)
        return {
            "x": _w((lambda *s: torch.randn(*s, dtype=torch.bfloat16) * 0.05)(B, Sq, D)),
            "k_cache": _w((lambda *s: torch.randn(*s, dtype=torch.bfloat16) * 3.2)(B, Hkv, Sk, Dh)),
            "v_cache": _w((lambda *s: torch.randn(*s, dtype=torch.bfloat16) * 0.05)(B, Hkv, Sk, Dh)),
            "wq": _w((lambda *s: torch.randn(*s, dtype=torch.bfloat16) * 3.2)(D, Hq * Dh) * (D ** -0.5)),
            "wo": _w((lambda *s: torch.randn(*s, dtype=torch.bfloat16) * 0.05)(Hq * Dh, D) * ((Hq * Dh) ** -0.5)),
        }
    _A_in = _A_setup()

    def _B_setup():
        B, Sq, D = 1, 1, 448
        Hq, Hkv, Sk, Dh = 16, 8, 8192, 256
        assert Hq % Hkv == 0, (Hq, Hkv)
        return {
            "x": _w((lambda *s: torch.randn(*s, dtype=torch.bfloat16) * 0.05)(B, Sq, D)),
            "k_cache": _w((lambda *s: torch.randn(*s, dtype=torch.bfloat16) * 3.2)(B, Hkv, Sk, Dh)),
            "v_cache": _w((lambda *s: torch.randn(*s, dtype=torch.bfloat16) * 0.05)(B, Hkv, Sk, Dh)),
            "wq": _w((lambda *s: torch.randn(*s, dtype=torch.bfloat16) * 3.2)(D, Hq * Dh) * (D ** -0.5)),
            "wo": _w((lambda *s: torch.randn(*s, dtype=torch.bfloat16) * 0.05)(Hq * Dh, D) * ((Hq * Dh) ** -0.5)),
        }
    _B_in = _B_setup()

    return {
        "A_x": _A_in["x"],
        "A_k_cache": _A_in["k_cache"],
        "A_v_cache": _A_in["v_cache"],
        "A_wq": _A_in["wq"],
        "A_wo": _A_in["wo"],
        "B_x": _B_in["x"],
        "B_k_cache": _B_in["k_cache"],
        "B_v_cache": _B_in["v_cache"],
        "B_wq": _B_in["wq"],
        "B_wo": _B_in["wo"],
        "gate_w": _w((lambda *s: torch.randn(*s, dtype=torch.bfloat16) * 0.1)(448) * 16.0),
    }

def reference(A_x, A_k_cache, A_v_cache, A_wq, A_wo, B_x, B_k_cache, B_v_cache, B_wq, B_wo, gate_w):
    def _A_ref(x, k_cache, v_cache, wq, wo):
        B, Sq, D = x.shape
        Hq, Dh = 16, 256
        Hkv, Sk = k_cache.shape[1], k_cache.shape[2]
        W = min(4096, max(256, Sk // 4))
        rep = Hq // Hkv
        q = (lambda x, *d: x.permute(*d))((x @ wq).reshape(B, Sq, Hq, Dh), 0, 2, 1, 3)
        k = (lambda x, n, axis: torch.repeat_interleave(x, n, dim=axis))(k_cache[:, :, Sk - W:, :], rep, axis=1)
        v = (lambda x, n, axis: torch.repeat_interleave(x, n, dim=axis))(v_cache[:, :, Sk - W:, :], rep, axis=1)
        scores = torch.einsum("bhqd,bhkd->bhqk", q, k) * (Dh ** -0.5)
        p = _softmax(scores, axis=-1)
        o = torch.einsum("bhqk,bhkd->bhqd", p, v)
        return (lambda x, *d: x.permute(*d))(o, 0, 2, 1, 3).reshape(B, Sq, Hq * Dh) @ wo

    def _B_ref(x, k_cache, v_cache, wq, wo):
        B, Sq, D = x.shape
        Hq, Dh = 16, 256
        Hkv = k_cache.shape[1]
        rep = Hq // Hkv
        q = (lambda x, *d: x.permute(*d))((x @ wq).reshape(B, Sq, Hq, Dh), 0, 2, 1, 3)
        k = (lambda x, n, axis: torch.repeat_interleave(x, n, dim=axis))(k_cache, rep, axis=1)
        v = (lambda x, n, axis: torch.repeat_interleave(x, n, dim=axis))(v_cache, rep, axis=1)
        scores = torch.einsum("bhqd,bhkd->bhqk", q, k) * (Dh ** -0.5)
        p = _softmax(scores, axis=-1)
        o = torch.einsum("bhqk,bhkd->bhqd", p, v)
        return (lambda x, *d: x.permute(*d))(o, 0, 2, 1, 3).reshape(B, Sq, Hq * Dh) @ wo

    x = A_x
    g = _sigmoid((x * gate_w).sum(-1, keepdims=True))
    a = _A_ref(x, A_k_cache, A_v_cache, A_wq, A_wo)
    b = _B_ref(x, B_k_cache, B_v_cache, B_wq, B_wo)
    return g * a + (1 - g) * b
```

```asm
; @launch grid=(256,1,1) block=(1024,1,1) lds=77824
.amdgcn_target "amdgcn-amd-amdhsa--gfx950"
.text
.globl gated_mix__sliding_block_cached__gqa_block_cached__decode_kernel
.p2align 8
.type gated_mix__sliding_block_cached__gqa_block_cached__decode_kernel,@function
gated_mix__sliding_block_cached__gqa_block_cached__decode_kernel:
    s_cmp_ge_u32 s2, 256
    s_cbranch_scc1 L_END
    s_load_dwordx16 s[16:31], s[0:1], 0
    s_load_dwordx8 s[32:39], s[0:1], 64
    s_load_dwordx4 s[40:43], s[0:1], 96
    v_lshrrev_b32 v1, 6, v0
    v_and_b32 v0, 63, v0
    v_readfirstlane_b32 s3, v1
    s_waitcnt lgkmcnt(0)
    s_mov_b32 s12, s42
    s_and_b32 s13, s43, 0xffff
    s_mov_b32 s14, 0x10000000
    s_mov_b32 s15, 0x00020000
    s_cmp_ge_u32 s2, 64
    s_cbranch_scc1 L_KVB
    s_lshr_b32 s45, s2, 3
    s_and_b32 s46, s2, 7
    s_lshl_b32 s47, s46, 8
    s_add_u32 s47, s47, 6144
    s_mov_b32 s92, 1
    s_mov_b32 s93, 17
    s_mov_b32 s101, s45
    s_mov_b32 s4, s18
    s_mov_b32 s5, s19
    s_mov_b32 s8, s20
    s_mov_b32 s9, s21
    s_branch L_KVC
L_KVB:
    s_sub_u32 s96, s2, 64
    s_mul_hi_u32 s45, s96, 0x0AAAAAAB
    s_mul_i32 s46, s45, 24
    s_sub_u32 s46, s96, s46
    s_mul_i32 s47, s46, 341
    s_min_u32 s92, s46, 8
    s_add_u32 s47, s47, s92
    s_cmp_lt_u32 s46, 8
    s_cselect_b32 s92, 12, 11
    s_mov_b32 s93, 22
    s_add_u32 s101, s45, 8
    s_mov_b32 s4, s28
    s_mov_b32 s5, s29
    s_mov_b32 s8, s30
    s_mov_b32 s9, s31
L_KVC:
    s_cmp_eq_u32 s3, 0
    s_cbranch_scc1 L_AUX
    s_sub_u32 s44, s3, 1
    s_mul_i32 s96, s93, s44
    s_add_u32 s47, s47, s96
    s_min_u32 s96, s44, s92
    s_add_u32 s47, s47, s96
    s_cmp_lt_u32 s44, s92
    s_cselect_b32 s96, 1, 0
    s_add_u32 s97, s93, s96
    s_lshl_b32 s98, s45, 22
    s_lshl_b32 s99, s47, 9
    s_add_u32 s98, s98, s99
    s_add_u32 s4, s4, s98
    s_addc_u32 s5, s5, 0
    s_and_b32 s5, s5, 0xffff
    s_lshl_b32 s6, s97, 9
    s_mov_b32 s7, 0x00020000
    s_add_u32 s8, s8, s98
    s_addc_u32 s9, s9, 0
    s_and_b32 s9, s9, 0xffff
    s_lshl_b32 s10, s97, 9
    s_mov_b32 s11, 0x00020000
    s_movk_i32 s99, 4096
    s_movk_i32 s100, 8192
    v_lshlrev_b32 v1, 3, v0
    s_barrier
    buffer_load_dwordx2 v[8:9], v1, s[4:7], 0 offen offset:0 nt
    buffer_load_dwordx2 v[10:11], v1, s[4:7], 0 offen offset:512 nt
    buffer_load_dwordx2 v[12:13], v1, s[4:7], 0 offen offset:1024 nt
    buffer_load_dwordx2 v[14:15], v1, s[4:7], 0 offen offset:1536 nt
    buffer_load_dwordx2 v[16:17], v1, s[4:7], 0 offen offset:2048 nt
    buffer_load_dwordx2 v[18:19], v1, s[4:7], 0 offen offset:2560 nt
    buffer_load_dwordx2 v[20:21], v1, s[4:7], 0 offen offset:3072 nt
    buffer_load_dwordx2 v[22:23], v1, s[4:7], 0 offen offset:3584 nt
    buffer_load_dwordx2 v[24:25], v1, s[4:7], s99 offen offset:0 nt
    buffer_load_dwordx2 v[26:27], v1, s[4:7], s99 offen offset:512 nt
    buffer_load_dwordx2 v[28:29], v1, s[4:7], s99 offen offset:1024 nt
    buffer_load_dwordx2 v[30:31], v1, s[4:7], s99 offen offset:1536 nt
    buffer_load_dwordx2 v[32:33], v1, s[4:7], s99 offen offset:2048 nt
    buffer_load_dwordx2 v[34:35], v1, s[4:7], s99 offen offset:2560 nt
    buffer_load_dwordx2 v[36:37], v1, s[4:7], s99 offen offset:3072 nt
    buffer_load_dwordx2 v[38:39], v1, s[4:7], s99 offen offset:3584 nt
    buffer_load_dwordx2 v[40:41], v1, s[4:7], s100 offen offset:0 nt
    buffer_load_dwordx2 v[42:43], v1, s[4:7], s100 offen offset:512 nt
    buffer_load_dwordx2 v[44:45], v1, s[4:7], s100 offen offset:1024 nt
    buffer_load_dwordx2 v[46:47], v1, s[4:7], s100 offen offset:1536 nt
    buffer_load_dwordx2 v[48:49], v1, s[4:7], s100 offen offset:2048 nt
    buffer_load_dwordx2 v[50:51], v1, s[4:7], s100 offen offset:2560 nt
    buffer_load_dwordx2 v[52:53], v1, s[4:7], s100 offen offset:3072 nt
    v_bfe_u32 v2, v0, 2, 1
    v_lshlrev_b32 v2, 2, v2
    v_bfe_u32 v3, v0, 3, 1
    v_lshlrev_b32 v3, 1, v3
    v_bfe_u32 v4, v0, 4, 1
    v_or_b32 v115, v2, v3
    v_or_b32 v115, v115, v4
    v_mov_b32 v104, 0
    v_mov_b32 v105, 0
    v_mov_b32 v106, 0
    v_mov_b32 v107, 0
    v_mov_b32 v108, 0
    v_mov_b32 v109, 0
    v_mov_b32 v110, 0
    v_mov_b32 v111, 0
    s_barrier
    ds_read_b64 v[100:101], v1 offset:0
    ds_read_b64 v[102:103], v1 offset:512
    v_mov_b32 v6, 0
    ds_read_b64 v[126:127], v6 offset:1024
    s_waitcnt lgkmcnt(0)
    v_readfirstlane_b32 s94, v126
    v_readfirstlane_b32 s95, v127
    s_waitcnt vmcnt(15)
    buffer_load_dwordx2 v[54:55], v1, s[8:11], 0 offen offset:0 nt
    buffer_load_dwordx2 v[56:57], v1, s[8:11], 0 offen offset:512 nt
    buffer_load_dwordx2 v[58:59], v1, s[8:11], 0 offen offset:1024 nt
    buffer_load_dwordx2 v[60:61], v1, s[8:11], 0 offen offset:1536 nt
    buffer_load_dwordx2 v[62:63], v1, s[8:11], 0 offen offset:2048 nt
    buffer_load_dwordx2 v[64:65], v1, s[8:11], 0 offen offset:2560 nt
    buffer_load_dwordx2 v[66:67], v1, s[8:11], 0 offen offset:3072 nt
    buffer_load_dwordx2 v[68:69], v1, s[8:11], 0 offen offset:3584 nt
    v_dot2_f32_bf16 v2, v9, v101, 0
    v_dot2_f32_bf16 v9, v9, v103, 0
    v_dot2_f32_bf16 v9, v8, v102, v9
    v_dot2_f32_bf16 v8, v8, v100, v2
    v_dot2_f32_bf16 v3, v11, v101, 0
    v_dot2_f32_bf16 v11, v11, v103, 0
    v_dot2_f32_bf16 v11, v10, v102, v11
    v_dot2_f32_bf16 v10, v10, v100, v3
    v_dot2_f32_bf16 v4, v13, v101, 0
    v_dot2_f32_bf16 v13, v13, v103, 0
    v_dot2_f32_bf16 v13, v12, v102, v13
    v_dot2_f32_bf16 v12, v12, v100, v4
    v_dot2_f32_bf16 v5, v15, v101, 0
    v_dot2_f32_bf16 v15, v15, v103, 0
    v_dot2_f32_bf16 v15, v14, v102, v15
    v_dot2_f32_bf16 v14, v14, v100, v5
    v_dot2_f32_bf16 v2, v17, v101, 0
    v_dot2_f32_bf16 v17, v17, v103, 0
    v_dot2_f32_bf16 v17, v16, v102, v17
    v_dot2_f32_bf16 v16, v16, v100, v2
    v_dot2_f32_bf16 v3, v19, v101, 0
    v_dot2_f32_bf16 v19, v19, v103, 0
    v_dot2_f32_bf16 v19, v18, v102, v19
    v_dot2_f32_bf16 v18, v18, v100, v3
    v_dot2_f32_bf16 v4, v21, v101, 0
    v_dot2_f32_bf16 v21, v21, v103, 0
    v_dot2_f32_bf16 v21, v20, v102, v21
    v_dot2_f32_bf16 v20, v20, v100, v4
    v_dot2_f32_bf16 v5, v23, v101, 0
    v_dot2_f32_bf16 v23, v23, v103, 0
    v_dot2_f32_bf16 v23, v22, v102, v23
    v_dot2_f32_bf16 v22, v22, v100, v5
    v_permlane32_swap_b32 v8, v9
    v_add_f32 v8, v8, v9
    v_permlane32_swap_b32 v10, v11
    v_add_f32 v10, v10, v11
    v_permlane32_swap_b32 v12, v13
    v_add_f32 v12, v12, v13
    v_permlane32_swap_b32 v14, v15
    v_add_f32 v14, v14, v15
    v_permlane32_swap_b32 v16, v17
    v_add_f32 v16, v16, v17
    v_permlane32_swap_b32 v18, v19
    v_add_f32 v18, v18, v19
    v_permlane32_swap_b32 v20, v21
    v_add_f32 v20, v20, v21
    v_permlane32_swap_b32 v22, v23
    v_add_f32 v22, v22, v23
    v_permlane16_swap_b32 v8, v10
    v_add_f32 v8, v8, v10
    v_permlane16_swap_b32 v12, v14
    v_add_f32 v12, v12, v14
    v_permlane16_swap_b32 v16, v18
    v_add_f32 v16, v16, v18
    v_permlane16_swap_b32 v20, v22
    v_add_f32 v20, v20, v22
    v_add_f32_dpp v8, v8, v8 row_ror:8 row_mask:0xf bank_mask:0x3
    v_add_f32_dpp v8, v12, v12 row_ror:8 row_mask:0xf bank_mask:0xc
    v_add_f32_dpp v16, v16, v16 row_ror:8 row_mask:0xf bank_mask:0x3
    v_add_f32_dpp v16, v20, v20 row_ror:8 row_mask:0xf bank_mask:0xc
    v_add_f32_dpp v8, v8, v8 row_shl:4 row_mask:0xf bank_mask:0x5
    s_nop 0
    v_add_f32_dpp v8, v16, v16 row_shr:4 row_mask:0xf bank_mask:0xa
    s_nop 1
    v_add_f32_dpp v112, v8, v8 quad_perm:[1,0,3,2] row_mask:0xf bank_mask:0xf
    s_nop 1
    v_add_f32_dpp v112, v112, v112 quad_perm:[2,3,0,1] row_mask:0xf bank_mask:0xf
    s_waitcnt vmcnt(15)
    buffer_load_dwordx2 v[70:71], v1, s[8:11], s99 offen offset:0 nt
    buffer_load_dwordx2 v[72:73], v1, s[8:11], s99 offen offset:512 nt
    buffer_load_dwordx2 v[74:75], v1, s[8:11], s99 offen offset:1024 nt
    buffer_load_dwordx2 v[76:77], v1, s[8:11], s99 offen offset:1536 nt
    buffer_load_dwordx2 v[78:79], v1, s[8:11], s99 offen offset:2048 nt
    buffer_load_dwordx2 v[80:81], v1, s[8:11], s99 offen offset:2560 nt
    buffer_load_dwordx2 v[82:83], v1, s[8:11], s99 offen offset:3072 nt
    buffer_load_dwordx2 v[84:85], v1, s[8:11], s99 offen offset:3584 nt
    v_dot2_f32_bf16 v2, v25, v101, 0
    v_dot2_f32_bf16 v25, v25, v103, 0
    v_dot2_f32_bf16 v25, v24, v102, v25
    v_dot2_f32_bf16 v24, v24, v100, v2
    v_dot2_f32_bf16 v3, v27, v101, 0
    v_dot2_f32_bf16 v27, v27, v103, 0
    v_dot2_f32_bf16 v27, v26, v102, v27
    v_dot2_f32_bf16 v26, v26, v100, v3
    v_dot2_f32_bf16 v4, v29, v101, 0
    v_dot2_f32_bf16 v29, v29, v103, 0
    v_dot2_f32_bf16 v29, v28, v102, v29
    v_dot2_f32_bf16 v28, v28, v100, v4
    v_dot2_f32_bf16 v5, v31, v101, 0
    v_dot2_f32_bf16 v31, v31, v103, 0
    v_dot2_f32_bf16 v31, v30, v102, v31
    v_dot2_f32_bf16 v30, v30, v100, v5
    v_dot2_f32_bf16 v2, v33, v101, 0
    v_dot2_f32_bf16 v33, v33, v103, 0
    v_dot2_f32_bf16 v33, v32, v102, v33
    v_dot2_f32_bf16 v32, v32, v100, v2
    v_dot2_f32_bf16 v3, v35, v101, 0
    v_dot2_f32_bf16 v35, v35, v103, 0
    v_dot2_f32_bf16 v35, v34, v102, v35
    v_dot2_f32_bf16 v34, v34, v100, v3
    v_dot2_f32_bf16 v4, v37, v101, 0
    v_dot2_f32_bf16 v37, v37, v103, 0
    v_dot2_f32_bf16 v37, v36, v102, v37
    v_dot2_f32_bf16 v36, v36, v100, v4
    v_dot2_f32_bf16 v5, v39, v101, 0
    v_dot2_f32_bf16 v39, v39, v103, 0
    v_dot2_f32_bf16 v39, v38, v102, v39
    v_dot2_f32_bf16 v38, v38, v100, v5
    v_permlane32_swap_b32 v24, v25
    v_add_f32 v24, v24, v25
    v_permlane32_swap_b32 v26, v27
    v_add_f32 v26, v26, v27
    v_permlane32_swap_b32 v28, v29
    v_add_f32 v28, v28, v29
    v_permlane32_swap_b32 v30, v31
    v_add_f32 v30, v30, v31
    v_permlane32_swap_b32 v32, v33
    v_add_f32 v32, v32, v33
    v_permlane32_swap_b32 v34, v35
    v_add_f32 v34, v34, v35
    v_permlane32_swap_b32 v36, v37
    v_add_f32 v36, v36, v37
    v_permlane32_swap_b32 v38, v39
    v_add_f32 v38, v38, v39
    v_permlane16_swap_b32 v24, v26
    v_add_f32 v24, v24, v26
    v_permlane16_swap_b32 v28, v30
    v_add_f32 v28, v28, v30
    v_permlane16_swap_b32 v32, v34
    v_add_f32 v32, v32, v34
    v_permlane16_swap_b32 v36, v38
    v_add_f32 v36, v36, v38
    v_add_f32_dpp v24, v24, v24 row_ror:8 row_mask:0xf bank_mask:0x3
    v_add_f32_dpp v24, v28, v28 row_ror:8 row_mask:0xf bank_mask:0xc
    v_add_f32_dpp v32, v32, v32 row_ror:8 row_mask:0xf bank_mask:0x3
    v_add_f32_dpp v32, v36, v36 row_ror:8 row_mask:0xf bank_mask:0xc
    v_add_f32_dpp v24, v24, v24 row_shl:4 row_mask:0xf bank_mask:0x5
    s_nop 0
    v_add_f32_dpp v24, v32, v32 row_shr:4 row_mask:0xf bank_mask:0xa
    s_nop 1
    v_add_f32_dpp v113, v24, v24 quad_perm:[1,0,3,2] row_mask:0xf bank_mask:0xf
    s_nop 1
    v_add_f32_dpp v113, v113, v113 quad_perm:[2,3,0,1] row_mask:0xf bank_mask:0xf
    s_waitcnt vmcnt(16)
    buffer_load_dwordx2 v[86:87], v1, s[8:11], s100 offen offset:0 nt
    buffer_load_dwordx2 v[88:89], v1, s[8:11], s100 offen offset:512 nt
    buffer_load_dwordx2 v[90:91], v1, s[8:11], s100 offen offset:1024 nt
    buffer_load_dwordx2 v[92:93], v1, s[8:11], s100 offen offset:1536 nt
    buffer_load_dwordx2 v[94:95], v1, s[8:11], s100 offen offset:2048 nt
    buffer_load_dwordx2 v[96:97], v1, s[8:11], s100 offen offset:2560 nt
    buffer_load_dwordx2 v[98:99], v1, s[8:11], s100 offen offset:3072 nt
    v_dot2_f32_bf16 v2, v41, v101, 0
    v_dot2_f32_bf16 v41, v41, v103, 0
    v_dot2_f32_bf16 v41, v40, v102, v41
    v_dot2_f32_bf16 v40, v40, v100, v2
    v_dot2_f32_bf16 v3, v43, v101, 0
    v_dot2_f32_bf16 v43, v43, v103, 0
    v_dot2_f32_bf16 v43, v42, v102, v43
    v_dot2_f32_bf16 v42, v42, v100, v3
    v_dot2_f32_bf16 v4, v45, v101, 0
    v_dot2_f32_bf16 v45, v45, v103, 0
    v_dot2_f32_bf16 v45, v44, v102, v45
    v_dot2_f32_bf16 v44, v44, v100, v4
    v_dot2_f32_bf16 v5, v47, v101, 0
    v_dot2_f32_bf16 v47, v47, v103, 0
    v_dot2_f32_bf16 v47, v46, v102, v47
    v_dot2_f32_bf16 v46, v46, v100, v5
    v_dot2_f32_bf16 v2, v49, v101, 0
    v_dot2_f32_bf16 v49, v49, v103, 0
    v_dot2_f32_bf16 v49, v48, v102, v49
    v_dot2_f32_bf16 v48, v48, v100, v2
    v_dot2_f32_bf16 v3, v51, v101, 0
    v_dot2_f32_bf16 v51, v51, v103, 0
    v_dot2_f32_bf16 v51, v50, v102, v51
    v_dot2_f32_bf16 v50, v50, v100, v3
    v_dot2_f32_bf16 v4, v53, v101, 0
    v_dot2_f32_bf16 v53, v53, v103, 0
    v_dot2_f32_bf16 v53, v52, v102, v53
    v_dot2_f32_bf16 v52, v52, v100, v4
    v_permlane32_swap_b32 v40, v41
    v_add_f32 v40, v40, v41
    v_permlane32_swap_b32 v42, v43
    v_add_f32 v42, v42, v43
    v_permlane32_swap_b32 v44, v45
    v_add_f32 v44, v44, v45
    v_permlane32_swap_b32 v46, v47
    v_add_f32 v46, v46, v47
    v_permlane32_swap_b32 v48, v49
    v_add_f32 v48, v48, v49
    v_permlane32_swap_b32 v50, v51
    v_add_f32 v50, v50, v51
    v_permlane32_swap_b32 v52, v53
    v_add_f32 v52, v52, v53
    v_permlane16_swap_b32 v40, v42
    v_add_f32 v40, v40, v42
    v_permlane16_swap_b32 v44, v46
    v_add_f32 v44, v44, v46
    v_permlane16_swap_b32 v48, v50
    v_add_f32 v48, v48, v50
    v_mov_b32 v53, v52
    s_nop 1
    v_permlane16_swap_b32 v52, v53
    v_add_f32 v52, v52, v53
    v_add_f32_dpp v40, v40, v40 row_ror:8 row_mask:0xf bank_mask:0x3
    v_add_f32_dpp v40, v44, v44 row_ror:8 row_mask:0xf bank_mask:0xc
    v_add_f32_dpp v48, v48, v48 row_ror:8 row_mask:0xf bank_mask:0x3
    v_add_f32_dpp v48, v52, v52 row_ror:8 row_mask:0xf bank_mask:0xc
    v_add_f32_dpp v40, v40, v40 row_shl:4 row_mask:0xf bank_mask:0x5
    s_nop 0
    v_add_f32_dpp v40, v48, v48 row_shr:4 row_mask:0xf bank_mask:0xa
    s_nop 1
    v_add_f32_dpp v114, v40, v40 quad_perm:[1,0,3,2] row_mask:0xf bank_mask:0xf
    s_nop 1
    v_add_f32_dpp v114, v114, v114 quad_perm:[2,3,0,1] row_mask:0xf bank_mask:0xf
    v_cvt_pk_bf16_f32 v126, v112, v112
    v_lshlrev_b32 v112, 16, v126
    v_mul_f32 v112, 0x3d800000, v112
    s_sub_u32 s96, s97, 0
    v_cmp_gt_u32 vcc, s96, v115
    v_mov_b32 v127, 0xff800000
    s_nop 0
    v_cndmask_b32 v112, v127, v112, vcc
    v_cvt_pk_bf16_f32 v126, v113, v113
    v_lshlrev_b32 v113, 16, v126
    v_mul_f32 v113, 0x3d800000, v113
    s_sub_u32 s96, s97, 8
    v_cmp_gt_u32 vcc, s96, v115
    v_mov_b32 v127, 0xff800000
    s_nop 0
    v_cndmask_b32 v113, v127, v113, vcc
    v_cvt_pk_bf16_f32 v126, v114, v114
    v_lshlrev_b32 v114, 16, v126
    v_mul_f32 v114, 0x3d800000, v114
    s_sub_u32 s96, s97, 16
    v_cmp_gt_u32 vcc, s96, v115
    v_mov_b32 v127, 0xff800000
    s_nop 0
    v_cndmask_b32 v114, v127, v114, vcc
    v_max3_f32 v124, v112, v113, v114
    s_nop 1
    v_max_f32_dpp v124, v124, v124 row_ror:4 row_mask:0xf bank_mask:0xf
    s_nop 1
    v_max_f32_dpp v124, v124, v124 row_ror:8 row_mask:0xf bank_mask:0xf
    v_mov_b32 v126, v124
    s_nop 1
    v_permlane16_swap_b32 v124, v126
    v_max_f32 v124, v124, v126
    v_sub_f32 v112, v112, v124
    v_mul_f32 v112, 0x3fb8aa3b, v112
    v_exp_f32 v112, v112
    v_sub_f32 v113, v113, v124
    v_mul_f32 v113, 0x3fb8aa3b, v113
    v_exp_f32 v113, v113
    v_sub_f32 v114, v114, v124
    v_mul_f32 v114, 0x3fb8aa3b, v114
    v_exp_f32 v114, v114
    v_add_f32 v125, v112, v113
    v_add_f32 v125, v125, v114
    s_nop 1
    v_add_f32_dpp v125, v125, v125 row_ror:4 row_mask:0xf bank_mask:0xf
    s_nop 1
    v_add_f32_dpp v125, v125, v125 row_ror:8 row_mask:0xf bank_mask:0xf
    v_mov_b32 v126, v125
    s_nop 1
    v_permlane16_swap_b32 v125, v126
    v_add_f32 v125, v125, v126
    v_readlane_b32 s48, v112, 0
    v_readlane_b32 s49, v112, 32
    v_readlane_b32 s50, v112, 16
    v_readlane_b32 s51, v112, 48
    v_readlane_b32 s52, v112, 8
    v_readlane_b32 s53, v112, 40
    v_readlane_b32 s54, v112, 24
    v_readlane_b32 s55, v112, 56
    v_readlane_b32 s56, v112, 4
    v_readlane_b32 s57, v112, 36
    v_readlane_b32 s58, v112, 20
    v_readlane_b32 s59, v112, 52
    v_readlane_b32 s60, v112, 12
    v_readlane_b32 s61, v112, 44
    v_readlane_b32 s62, v112, 28
    v_readlane_b32 s63, v112, 60
    v_readlane_b32 s64, v113, 0
    v_readlane_b32 s65, v113, 32
    v_readlane_b32 s66, v113, 16
    v_readlane_b32 s67, v113, 48
    v_readlane_b32 s68, v113, 8
    v_readlane_b32 s69, v113, 40
    v_readlane_b32 s70, v113, 24
    v_readlane_b32 s71, v113, 56
    v_readlane_b32 s72, v113, 4
    v_readlane_b32 s73, v113, 36
    v_readlane_b32 s74, v113, 20
    v_readlane_b32 s75, v113, 52
    v_readlane_b32 s76, v113, 12
    v_readlane_b32 s77, v113, 44
    v_readlane_b32 s78, v113, 28
    v_readlane_b32 s79, v113, 60
    v_readlane_b32 s80, v114, 0
    v_readlane_b32 s81, v114, 32
    v_readlane_b32 s82, v114, 16
    v_readlane_b32 s83, v114, 48
    v_readlane_b32 s84, v114, 8
    v_readlane_b32 s85, v114, 40
    v_readlane_b32 s86, v114, 24
    v_readlane_b32 s87, v114, 56
    v_readlane_b32 s88, v114, 4
    v_readlane_b32 s89, v114, 36
    v_readlane_b32 s90, v114, 20
    v_readlane_b32 s91, v114, 52
    v_readlane_b32 s92, v114, 12
    v_readlane_b32 s93, v114, 44
    s_waitcnt vmcnt(22)
    v_lshlrev_b32 v116, 16, v54
    v_and_b32 v117, 0xffff0000, v54
    v_lshlrev_b32 v118, 16, v55
    v_and_b32 v119, 0xffff0000, v55
    v_pk_fma_f32 v[104:105], v[116:117], s[48:49], v[104:105] op_sel_hi:[1,0,1]
    v_pk_fma_f32 v[106:107], v[118:119], s[48:49], v[106:107] op_sel_hi:[1,0,1]
    v_pk_fma_f32 v[108:109], v[116:117], s[48:49], v[108:109] op_sel:[0,1,0] op_sel_hi:[1,1,1]
    v_pk_fma_f32 v[110:111], v[118:119], s[48:49], v[110:111] op_sel:[0,1,0] op_sel_hi:[1,1,1]
    s_waitcnt vmcnt(21)
    v_lshlrev_b32 v120, 16, v56
    v_and_b32 v121, 0xffff0000, v56
    v_lshlrev_b32 v122, 16, v57
    v_and_b32 v123, 0xffff0000, v57
    v_pk_fma_f32 v[104:105], v[120:121], s[50:51], v[104:105] op_sel_hi:[1,0,1]
    v_pk_fma_f32 v[106:107], v[122:123], s[50:51], v[106:107] op_sel_hi:[1,0,1]
    v_pk_fma_f32 v[108:109], v[120:121], s[50:51], v[108:109] op_sel:[0,1,0] op_sel_hi:[1,1,1]
    v_pk_fma_f32 v[110:111], v[122:123], s[50:51], v[110:111] op_sel:[0,1,0] op_sel_hi:[1,1,1]
    s_waitcnt vmcnt(20)
    v_lshlrev_b32 v116, 16, v58
    v_and_b32 v117, 0xffff0000, v58
    v_lshlrev_b32 v118, 16, v59
    v_and_b32 v119, 0xffff0000, v59
    v_pk_fma_f32 v[104:105], v[116:117], s[52:53], v[104:105] op_sel_hi:[1,0,1]
    v_pk_fma_f32 v[106:107], v[118:119], s[52:53], v[106:107] op_sel_hi:[1,0,1]
    v_pk_fma_f32 v[108:109], v[116:117], s[52:53], v[108:109] op_sel:[0,1,0] op_sel_hi:[1,1,1]
    v_pk_fma_f32 v[110:111], v[118:119], s[52:53], v[110:111] op_sel:[0,1,0] op_sel_hi:[1,1,1]
    s_waitcnt vmcnt(19)
    v_lshlrev_b32 v120, 16, v60
    v_and_b32 v121, 0xffff0000, v60
    v_lshlrev_b32 v122, 16, v61
    v_and_b32 v123, 0xffff0000, v61
    v_pk_fma_f32 v[104:105], v[120:121], s[54:55], v[104:105] op_sel_hi:[1,0,1]
    v_pk_fma_f32 v[106:107], v[122:123], s[54:55], v[106:107] op_sel_hi:[1,0,1]
    v_pk_fma_f32 v[108:109], v[120:121], s[54:55], v[108:109] op_sel:[0,1,0] op_sel_hi:[1,1,1]
    v_pk_fma_f32 v[110:111], v[122:123], s[54:55], v[110:111] op_sel:[0,1,0] op_sel_hi:[1,1,1]
    s_waitcnt vmcnt(18)
    v_lshlrev_b32 v116, 16, v62
    v_and_b32 v117, 0xffff0000, v62
    v_lshlrev_b32 v118, 16, v63
    v_and_b32 v119, 0xffff0000, v63
    v_pk_fma_f32 v[104:105], v[116:117], s[56:57], v[104:105] op_sel_hi:[1,0,1]
    v_pk_fma_f32 v[106:107], v[118:119], s[56:57], v[106:107] op_sel_hi:[1,0,1]
    v_pk_fma_f32 v[108:109], v[116:117], s[56:57], v[108:109] op_sel:[0,1,0] op_sel_hi:[1,1,1]
    v_pk_fma_f32 v[110:111], v[118:119], s[56:57], v[110:111] op_sel:[0,1,0] op_sel_hi:[1,1,1]
    s_waitcnt vmcnt(17)
    v_lshlrev_b32 v120, 16, v64
    v_and_b32 v121, 0xffff0000, v64
    v_lshlrev_b32 v122, 16, v65
    v_and_b32 v123, 0xffff0000, v65
    v_pk_fma_f32 v[104:105], v[120:121], s[58:59], v[104:105] op_sel_hi:[1,0,1]
    v_pk_fma_f32 v[106:107], v[122:123], s[58:59], v[106:107] op_sel_hi:[1,0,1]
    v_pk_fma_f32 v[108:109], v[120:121], s[58:59], v[108:109] op_sel:[0,1,0] op_sel_hi:[1,1,1]
    v_pk_fma_f32 v[110:111], v[122:123], s[58:59], v[110:111] op_sel:[0,1,0] op_sel_hi:[1,1,1]
    s_waitcnt vmcnt(16)
    v_lshlrev_b32 v116, 16, v66
    v_and_b32 v117, 0xffff0000, v66
    v_lshlrev_b32 v118, 16, v67
    v_and_b32 v119, 0xffff0000, v67
    v_pk_fma_f32 v[104:105], v[116:117], s[60:61], v[104:105] op_sel_hi:[1,0,1]
    v_pk_fma_f32 v[106:107], v[118:119], s[60:61], v[106:107] op_sel_hi:[1,0,1]
    v_pk_fma_f32 v[108:109], v[116:117], s[60:61], v[108:109] op_sel:[0,1,0] op_sel_hi:[1,1,1]
    v_pk_fma_f32 v[110:111], v[118:119], s[60:61], v[110:111] op_sel:[0,1,0] op_sel_hi:[1,1,1]
    s_waitcnt vmcnt(15)
    v_lshlrev_b32 v120, 16, v68
    v_and_b32 v121, 0xffff0000, v68
    v_lshlrev_b32 v122, 16, v69
    v_and_b32 v123, 0xffff0000, v69
    v_pk_fma_f32 v[104:105], v[120:121], s[62:63], v[104:105] op_sel_hi:[1,0,1]
    v_pk_fma_f32 v[106:107], v[122:123], s[62:63], v[106:107] op_sel_hi:[1,0,1]
    v_pk_fma_f32 v[108:109], v[120:121], s[62:63], v[108:109] op_sel:[0,1,0] op_sel_hi:[1,1,1]
    v_pk_fma_f32 v[110:111], v[122:123], s[62:63], v[110:111] op_sel:[0,1,0] op_sel_hi:[1,1,1]
    s_waitcnt vmcnt(14)
    v_lshlrev_b32 v116, 16, v70
    v_and_b32 v117, 0xffff0000, v70
    v_lshlrev_b32 v118, 16, v71
    v_and_b32 v119, 0xffff0000, v71
    v_pk_fma_f32 v[104:105], v[116:117], s[64:65], v[104:105] op_sel_hi:[1,0,1]
    v_pk_fma_f32 v[106:107], v[118:119], s[64:65], v[106:107] op_sel_hi:[1,0,1]
    v_pk_fma_f32 v[108:109], v[116:117], s[64:65], v[108:109] op_sel:[0,1,0] op_sel_hi:[1,1,1]
    v_pk_fma_f32 v[110:111], v[118:119], s[64:65], v[110:111] op_sel:[0,1,0] op_sel_hi:[1,1,1]
    s_waitcnt vmcnt(13)
    v_lshlrev_b32 v120, 16, v72
    v_and_b32 v121, 0xffff0000, v72
    v_lshlrev_b32 v122, 16, v73
    v_and_b32 v123, 0xffff0000, v73
    v_pk_fma_f32 v[104:105], v[120:121], s[66:67], v[104:105] op_sel_hi:[1,0,1]
    v_pk_fma_f32 v[106:107], v[122:123], s[66:67], v[106:107] op_sel_hi:[1,0,1]
    v_pk_fma_f32 v[108:109], v[120:121], s[66:67], v[108:109] op_sel:[0,1,0] op_sel_hi:[1,1,1]
    v_pk_fma_f32 v[110:111], v[122:123], s[66:67], v[110:111] op_sel:[0,1,0] op_sel_hi:[1,1,1]
    s_waitcnt vmcnt(12)
    v_lshlrev_b32 v116, 16, v74
    v_and_b32 v117, 0xffff0000, v74
    v_lshlrev_b32 v118, 16, v75
    v_and_b32 v119, 0xffff0000, v75
    v_pk_fma_f32 v[104:105], v[116:117], s[68:69], v[104:105] op_sel_hi:[1,0,1]
    v_pk_fma_f32 v[106:107], v[118:119], s[68:69], v[106:107] op_sel_hi:[1,0,1]
    v_pk_fma_f32 v[108:109], v[116:117], s[68:69], v[108:109] op_sel:[0,1,0] op_sel_hi:[1,1,1]
    v_pk_fma_f32 v[110:111], v[118:119], s[68:69], v[110:111] op_sel:[0,1,0] op_sel_hi:[1,1,1]
    s_waitcnt vmcnt(11)
    v_lshlrev_b32 v120, 16, v76
    v_and_b32 v121, 0xffff0000, v76
    v_lshlrev_b32 v122, 16, v77
    v_and_b32 v123, 0xffff0000, v77
    v_pk_fma_f32 v[104:105], v[120:121], s[70:71], v[104:105] op_sel_hi:[1,0,1]
    v_pk_fma_f32 v[106:107], v[122:123], s[70:71], v[106:107] op_sel_hi:[1,0,1]
    v_pk_fma_f32 v[108:109], v[120:121], s[70:71], v[108:109] op_sel:[0,1,0] op_sel_hi:[1,1,1]
    v_pk_fma_f32 v[110:111], v[122:123], s[70:71], v[110:111] op_sel:[0,1,0] op_sel_hi:[1,1,1]
    s_waitcnt vmcnt(10)
    v_lshlrev_b32 v116, 16, v78
    v_and_b32 v117, 0xffff0000, v78
    v_lshlrev_b32 v118, 16, v79
    v_and_b32 v119, 0xffff0000, v79
    v_pk_fma_f32 v[104:105], v[116:117], s[72:73], v[104:105] op_sel_hi:[1,0,1]
    v_pk_fma_f32 v[106:107], v[118:119], s[72:73], v[106:107] op_sel_hi:[1,0,1]
    v_pk_fma_f32 v[108:109], v[116:117], s[72:73], v[108:109] op_sel:[0,1,0] op_sel_hi:[1,1,1]
    v_pk_fma_f32 v[110:111], v[118:119], s[72:73], v[110:111] op_sel:[0,1,0] op_sel_hi:[1,1,1]
    s_waitcnt vmcnt(9)
    v_lshlrev_b32 v120, 16, v80
    v_and_b32 v121, 0xffff0000, v80
    v_lshlrev_b32 v122, 16, v81
    v_and_b32 v123, 0xffff0000, v81
    v_pk_fma_f32 v[104:105], v[120:121], s[74:75], v[104:105] op_sel_hi:[1,0,1]
    v_pk_fma_f32 v[106:107], v[122:123], s[74:75], v[106:107] op_sel_hi:[1,0,1]
    v_pk_fma_f32 v[108:109], v[120:121], s[74:75], v[108:109] op_sel:[0,1,0] op_sel_hi:[1,1,1]
    v_pk_fma_f32 v[110:111], v[122:123], s[74:75], v[110:111] op_sel:[0,1,0] op_sel_hi:[1,1,1]
    s_waitcnt vmcnt(8)
    v_lshlrev_b32 v116, 16, v82
    v_and_b32 v117, 0xffff0000, v82
    v_lshlrev_b32 v118, 16, v83
    v_and_b32 v119, 0xffff0000, v83
    v_pk_fma_f32 v[104:105], v[116:117], s[76:77], v[104:105] op_sel_hi:[1,0,1]
    v_pk_fma_f32 v[106:107], v[118:119], s[76:77], v[106:107] op_sel_hi:[1,0,1]
    v_pk_fma_f32 v[108:109], v[116:117], s[76:77], v[108:109] op_sel:[0,1,0] op_sel_hi:[1,1,1]
    v_pk_fma_f32 v[110:111], v[118:119], s[76:77], v[110:111] op_sel:[0,1,0] op_sel_hi:[1,1,1]
    s_waitcnt vmcnt(7)
    v_lshlrev_b32 v120, 16, v84
    v_and_b32 v121, 0xffff0000, v84
    v_lshlrev_b32 v122, 16, v85
    v_and_b32 v123, 0xffff0000, v85
    v_pk_fma_f32 v[104:105], v[120:121], s[78:79], v[104:105] op_sel_hi:[1,0,1]
    v_pk_fma_f32 v[106:107], v[122:123], s[78:79], v[106:107] op_sel_hi:[1,0,1]
    v_pk_fma_f32 v[108:109], v[120:121], s[78:79], v[108:109] op_sel:[0,1,0] op_sel_hi:[1,1,1]
    v_pk_fma_f32 v[110:111], v[122:123], s[78:79], v[110:111] op_sel:[0,1,0] op_sel_hi:[1,1,1]
    s_waitcnt vmcnt(6)
    v_lshlrev_b32 v116, 16, v86
    v_and_b32 v117, 0xffff0000, v86
    v_lshlrev_b32 v118, 16, v87
    v_and_b32 v119, 0xffff0000, v87
    v_pk_fma_f32 v[104:105], v[116:117], s[80:81], v[104:105] op_sel_hi:[1,0,1]
    v_pk_fma_f32 v[106:107], v[118:119], s[80:81], v[106:107] op_sel_hi:[1,0,1]
    v_pk_fma_f32 v[108:109], v[116:117], s[80:81], v[108:109] op_sel:[0,1,0] op_sel_hi:[1,1,1]
    v_pk_fma_f32 v[110:111], v[118:119], s[80:81], v[110:111] op_sel:[0,1,0] op_sel_hi:[1,1,1]
    s_waitcnt vmcnt(5)
    v_lshlrev_b32 v120, 16, v88
    v_and_b32 v121, 0xffff0000, v88
    v_lshlrev_b32 v122, 16, v89
    v_and_b32 v123, 0xffff0000, v89
    v_pk_fma_f32 v[104:105], v[120:121], s[82:83], v[104:105] op_sel_hi:[1,0,1]
    v_pk_fma_f32 v[106:107], v[122:123], s[82:83], v[106:107] op_sel_hi:[1,0,1]
    v_pk_fma_f32 v[108:109], v[120:121], s[82:83], v[108:109] op_sel:[0,1,0] op_sel_hi:[1,1,1]
    v_pk_fma_f32 v[110:111], v[122:123], s[82:83], v[110:111] op_sel:[0,1,0] op_sel_hi:[1,1,1]
    s_waitcnt vmcnt(4)
    v_lshlrev_b32 v116, 16, v90
    v_and_b32 v117, 0xffff0000, v90
    v_lshlrev_b32 v118, 16, v91
    v_and_b32 v119, 0xffff0000, v91
    v_pk_fma_f32 v[104:105], v[116:117], s[84:85], v[104:105] op_sel_hi:[1,0,1]
    v_pk_fma_f32 v[106:107], v[118:119], s[84:85], v[106:107] op_sel_hi:[1,0,1]
    v_pk_fma_f32 v[108:109], v[116:117], s[84:85], v[108:109] op_sel:[0,1,0] op_sel_hi:[1,1,1]
    v_pk_fma_f32 v[110:111], v[118:119], s[84:85], v[110:111] op_sel:[0,1,0] op_sel_hi:[1,1,1]
    s_waitcnt vmcnt(3)
    v_lshlrev_b32 v120, 16, v92
    v_and_b32 v121, 0xffff0000, v92
    v_lshlrev_b32 v122, 16, v93
    v_and_b32 v123, 0xffff0000, v93
    v_pk_fma_f32 v[104:105], v[120:121], s[86:87], v[104:105] op_sel_hi:[1,0,1]
    v_pk_fma_f32 v[106:107], v[122:123], s[86:87], v[106:107] op_sel_hi:[1,0,1]
    v_pk_fma_f32 v[108:109], v[120:121], s[86:87], v[108:109] op_sel:[0,1,0] op_sel_hi:[1,1,1]
    v_pk_fma_f32 v[110:111], v[122:123], s[86:87], v[110:111] op_sel:[0,1,0] op_sel_hi:[1,1,1]
    s_waitcnt vmcnt(2)
    v_lshlrev_b32 v116, 16, v94
    v_and_b32 v117, 0xffff0000, v94
    v_lshlrev_b32 v118, 16, v95
    v_and_b32 v119, 0xffff0000, v95
    v_pk_fma_f32 v[104:105], v[116:117], s[88:89], v[104:105] op_sel_hi:[1,0,1]
    v_pk_fma_f32 v[106:107], v[118:119], s[88:89], v[106:107] op_sel_hi:[1,0,1]
    v_pk_fma_f32 v[108:109], v[116:117], s[88:89], v[108:109] op_sel:[0,1,0] op_sel_hi:[1,1,1]
    v_pk_fma_f32 v[110:111], v[118:119], s[88:89], v[110:111] op_sel:[0,1,0] op_sel_hi:[1,1,1]
    s_waitcnt vmcnt(1)
    v_lshlrev_b32 v120, 16, v96
    v_and_b32 v121, 0xffff0000, v96
    v_lshlrev_b32 v122, 16, v97
    v_and_b32 v123, 0xffff0000, v97
    v_pk_fma_f32 v[104:105], v[120:121], s[90:91], v[104:105] op_sel_hi:[1,0,1]
    v_pk_fma_f32 v[106:107], v[122:123], s[90:91], v[106:107] op_sel_hi:[1,0,1]
    v_pk_fma_f32 v[108:109], v[120:121], s[90:91], v[108:109] op_sel:[0,1,0] op_sel_hi:[1,1,1]
    v_pk_fma_f32 v[110:111], v[122:123], s[90:91], v[110:111] op_sel:[0,1,0] op_sel_hi:[1,1,1]
    s_waitcnt vmcnt(0)
    v_lshlrev_b32 v116, 16, v98
    v_and_b32 v117, 0xffff0000, v98
    v_lshlrev_b32 v118, 16, v99
    v_and_b32 v119, 0xffff0000, v99
    v_pk_fma_f32 v[104:105], v[116:117], s[92:93], v[104:105] op_sel_hi:[1,0,1]
    v_pk_fma_f32 v[106:107], v[118:119], s[92:93], v[106:107] op_sel_hi:[1,0,1]
    v_pk_fma_f32 v[108:109], v[116:117], s[92:93], v[108:109] op_sel:[0,1,0] op_sel_hi:[1,1,1]
    v_pk_fma_f32 v[110:111], v[118:119], s[92:93], v[110:111] op_sel:[0,1,0] op_sel_hi:[1,1,1]
    s_lshl_b32 s96, s44, 11
    v_lshlrev_b32 v2, 4, v0
    v_add_u32 v2, s96, v2
    ds_write_b128 v2, v[104:107] offset:4096
    ds_write_b128 v2, v[108:111] offset:5120
    s_lshl_b32 s96, s44, 4
    v_lshrrev_b32 v3, 5, v0
    v_lshlrev_b32 v3, 3, v3
    v_add_u32 v3, s96, v3
    ds_write_b64 v3, v[124:125] offset:1280
    s_waitcnt lgkmcnt(0)
    s_barrier
    s_branch L_TAIL
L_AUX:
    s_memrealtime s[96:97]
    s_mov_b32 s8, s40
    s_and_b32 s9, s41, 0xffff
    s_mov_b32 s10, 256
    s_mov_b32 s11, 0x00020000
    s_lshr_b32 s44, s2, 7
    s_cmp_eq_u32 s44, 0
    s_cselect_b32 s4, s22, s32
    s_cselect_b32 s5, s23, s33
    s_and_b32 s5, s5, 0xffff
    s_mov_b32 s6, 3670016
    s_mov_b32 s7, 0x00020000
    s_mov_b32 s48, s16
    s_and_b32 s49, s17, 0xffff
    s_mov_b32 s50, 896
    s_mov_b32 s51, 0x00020000
    v_lshrrev_b32 v1, 2, v0
    v_and_b32 v2, 3, v0
    v_mul_u32_u24 v7, 0x38000, v1
    v_lshl_add_u32 v7, v2, 4, v7
    v_mul_u32_u24 v8, 56, v1
    v_mov_b32 v28, 0
    s_waitcnt lgkmcnt(0)
    s_or_b32 s96, s96, 1
    s_cmp_lg_u32 s2, 0
    s_cbranch_scc1 L_NONCE_POLL0
    v_mov_b32 v24, s96
    v_mov_b32 v25, s97
    s_mov_b64 exec, 1
    buffer_store_dwordx2 v[24:25], v28, s[8:11], 0 offen sc1
    s_mov_b64 exec, -1
L_NONCE_POLL0:
    s_nop 4
    buffer_load_dwordx4 v[24:27], v28, s[8:11], 0 offen sc1
    buffer_load_dwordx2 v[10:11], v8, s[48:51], 0 offen offset:0
    buffer_load_dwordx2 v[12:13], v8, s[48:51], 0 offen offset:8
    buffer_load_dwordx2 v[14:15], v8, s[48:51], 0 offen offset:16
    buffer_load_dwordx2 v[16:17], v8, s[48:51], 0 offen offset:24
    buffer_load_dwordx2 v[18:19], v8, s[48:51], 0 offen offset:32
    buffer_load_dwordx2 v[20:21], v8, s[48:51], 0 offen offset:40
    buffer_load_dwordx2 v[22:23], v8, s[48:51], 0 offen offset:48
    s_and_b32 s46, s2, 127
    s_lshl_b32 s46, s46, 6
    s_mov_b32 m0, 4096
    s_nop 0
    buffer_load_dwordx4 v7, s[4:7], s46 offen lds
    s_add_u32 s46, s46, 8192
    s_mov_b32 m0, 5120
    s_nop 0
    buffer_load_dwordx4 v7, s[4:7], s46 offen lds
    s_add_u32 s46, s46, 8192
    s_mov_b32 m0, 6144
    s_nop 0
    buffer_load_dwordx4 v7, s[4:7], s46 offen lds
    s_add_u32 s46, s46, 8192
    s_mov_b32 m0, 7168
    s_nop 0
    buffer_load_dwordx4 v7, s[4:7], s46 offen lds
    s_add_u32 s46, s46, 8192
    s_mov_b32 m0, 8192
    s_nop 0
    buffer_load_dwordx4 v7, s[4:7], s46 offen lds
    s_add_u32 s46, s46, 8192
    s_mov_b32 m0, 9216
    s_nop 0
    buffer_load_dwordx4 v7, s[4:7], s46 offen lds
    s_add_u32 s46, s46, 8192
    s_mov_b32 m0, 10240
    s_nop 0
    buffer_load_dwordx4 v7, s[4:7], s46 offen lds
    s_add_u32 s46, s46, 8192
    s_mov_b32 m0, 11264
    s_nop 0
    buffer_load_dwordx4 v7, s[4:7], s46 offen lds
    s_add_u32 s46, s46, 8192
    s_mov_b32 m0, 12288
    s_nop 0
    buffer_load_dwordx4 v7, s[4:7], s46 offen lds
    s_add_u32 s46, s46, 8192
    s_mov_b32 m0, 13312
    s_nop 0
    buffer_load_dwordx4 v7, s[4:7], s46 offen lds
    s_add_u32 s46, s46, 8192
    s_mov_b32 m0, 14336
    s_nop 0
    buffer_load_dwordx4 v7, s[4:7], s46 offen lds
    s_add_u32 s46, s46, 8192
    s_mov_b32 m0, 15360
    s_nop 0
    buffer_load_dwordx4 v7, s[4:7], s46 offen lds
    s_add_u32 s46, s46, 8192
    s_mov_b32 m0, 16384
    s_nop 0
    buffer_load_dwordx4 v7, s[4:7], s46 offen lds
    s_add_u32 s46, s46, 8192
    s_mov_b32 m0, 17408
    s_nop 0
    buffer_load_dwordx4 v7, s[4:7], s46 offen lds
    s_add_u32 s46, s46, 8192
    s_mov_b32 m0, 18432
    s_nop 0
    buffer_load_dwordx4 v7, s[4:7], s46 offen lds
    s_add_u32 s46, s46, 8192
    s_mov_b32 m0, 19456
    s_nop 0
    buffer_load_dwordx4 v7, s[4:7], s46 offen lds
    s_add_u32 s46, s46, 8192
    s_mov_b32 m0, 20480
    s_nop 0
    buffer_load_dwordx4 v7, s[4:7], s46 offen lds
    s_add_u32 s46, s46, 8192
    s_mov_b32 m0, 21504
    s_nop 0
    buffer_load_dwordx4 v7, s[4:7], s46 offen lds
    s_add_u32 s46, s46, 8192
    s_mov_b32 m0, 22528
    s_nop 0
    buffer_load_dwordx4 v7, s[4:7], s46 offen lds
    s_add_u32 s46, s46, 8192
    s_mov_b32 m0, 23552
    s_nop 0
    buffer_load_dwordx4 v7, s[4:7], s46 offen lds
    s_add_u32 s46, s46, 8192
    s_mov_b32 m0, 24576
    s_nop 0
    buffer_load_dwordx4 v7, s[4:7], s46 offen lds
    s_add_u32 s46, s46, 8192
    s_mov_b32 m0, 25600
    s_nop 0
    buffer_load_dwordx4 v7, s[4:7], s46 offen lds
    s_add_u32 s46, s46, 8192
    s_mov_b32 m0, 26624
    s_nop 0
    buffer_load_dwordx4 v7, s[4:7], s46 offen lds
    s_add_u32 s46, s46, 8192
    s_mov_b32 m0, 27648
    s_nop 0
    buffer_load_dwordx4 v7, s[4:7], s46 offen lds
    s_add_u32 s46, s46, 8192
    s_mov_b32 m0, 28672
    s_nop 0
    buffer_load_dwordx4 v7, s[4:7], s46 offen lds
    s_add_u32 s46, s46, 8192
    s_mov_b32 m0, 29696
    s_nop 0
    buffer_load_dwordx4 v7, s[4:7], s46 offen lds
    s_add_u32 s46, s46, 8192
    s_mov_b32 m0, 30720
    s_nop 0
    buffer_load_dwordx4 v7, s[4:7], s46 offen lds
    s_add_u32 s46, s46, 8192
    s_mov_b32 m0, 31744
    s_nop 0
    buffer_load_dwordx4 v7, s[4:7], s46 offen lds
    s_barrier
    v_lshlrev_b32 v9, 4, v0
    s_waitcnt vmcnt(0)
    s_mov_b32 s53, 0
L_NONCE_CHK:
    s_nop 2
    v_readfirstlane_b32 s98, v24
    v_readfirstlane_b32 s99, v25
    s_cmp_eq_u64 s[98:99], 0
    s_cbranch_scc0 L_NONCE_OK
    s_add_u32 s53, s53, 1
    s_cmp_lt_u32 s53, 30000
    s_cbranch_scc0 L_NONCE_OK
    buffer_load_dwordx4 v[24:27], v28, s[8:11], 0 offen sc1
    s_waitcnt vmcnt(0)
    s_branch L_NONCE_CHK
L_NONCE_OK:
    s_mov_b32 s94, s98
    s_mov_b32 s95, s99
    s_nop 0
    v_mov_b32 v24, s94
    v_mov_b32 v25, s95
    ds_write_b64 v28, v[24:25] offset:1024
    v_mov_b32 v80, 0
    v_mov_b32 v81, 0
    v_mov_b32 v82, 0
    v_mov_b32 v83, 0
    v_mov_b32 v84, 0
    v_mov_b32 v85, 0
    v_mov_b32 v86, 0
    v_mov_b32 v87, 0
    ds_read_b128 v[32:35], v9 offset:4096
    ds_read_b128 v[36:39], v9 offset:5120
    ds_read_b128 v[40:43], v9 offset:6144
    ds_read_b128 v[44:47], v9 offset:7168
    s_waitcnt lgkmcnt(3)
    v_lshlrev_b32 v90, 16, v10
    v_lshlrev_b32 v48, 16, v32
    v_and_b32 v49, 0xffff0000, v32
    v_lshlrev_b32 v50, 16, v33
    v_and_b32 v51, 0xffff0000, v33
    v_lshlrev_b32 v52, 16, v34
    v_and_b32 v53, 0xffff0000, v34
    v_lshlrev_b32 v54, 16, v35
    v_and_b32 v55, 0xffff0000, v35
    ds_read_b128 v[32:35], v9 offset:8192
    v_pk_fma_f32 v[80:81], v[48:49], v[90:91], v[80:81] op_sel_hi:[1,0,1]
    v_pk_fma_f32 v[82:83], v[50:51], v[90:91], v[82:83] op_sel_hi:[1,0,1]
    v_pk_fma_f32 v[84:85], v[52:53], v[90:91], v[84:85] op_sel_hi:[1,0,1]
    v_pk_fma_f32 v[86:87], v[54:55], v[90:91], v[86:87] op_sel_hi:[1,0,1]
    s_waitcnt lgkmcnt(3)
    v_and_b32 v90, 0xffff0000, v10
    v_lshlrev_b32 v48, 16, v36
    v_and_b32 v49, 0xffff0000, v36
    v_lshlrev_b32 v50, 16, v37
    v_and_b32 v51, 0xffff0000, v37
    v_lshlrev_b32 v52, 16, v38
    v_and_b32 v53, 0xffff0000, v38
    v_lshlrev_b32 v54, 16, v39
    v_and_b32 v55, 0xffff0000, v39
    ds_read_b128 v[36:39], v9 offset:9216
    v_pk_fma_f32 v[80:81], v[48:49], v[90:91], v[80:81] op_sel_hi:[1,0,1]
    v_pk_fma_f32 v[82:83], v[50:51], v[90:91], v[82:83] op_sel_hi:[1,0,1]
    v_pk_fma_f32 v[84:85], v[52:53], v[90:91], v[84:85] op_sel_hi:[1,0,1]
    v_pk_fma_f32 v[86:87], v[54:55], v[90:91], v[86:87] op_sel_hi:[1,0,1]
    s_waitcnt lgkmcnt(3)
    v_lshlrev_b32 v90, 16, v11
    v_lshlrev_b32 v48, 16, v40
    v_and_b32 v49, 0xffff0000, v40
    v_lshlrev_b32 v50, 16, v41
    v_and_b32 v51, 0xffff0000, v41
    v_lshlrev_b32 v52, 16, v42
    v_and_b32 v53, 0xffff0000, v42
    v_lshlrev_b32 v54, 16, v43
    v_and_b32 v55, 0xffff0000, v43
    ds_read_b128 v[40:43], v9 offset:10240
    v_pk_fma_f32 v[80:81], v[48:49], v[90:91], v[80:81] op_sel_hi:[1,0,1]
    v_pk_fma_f32 v[82:83], v[50:51], v[90:91], v[82:83] op_sel_hi:[1,0,1]
    v_pk_fma_f32 v[84:85], v[52:53], v[90:91], v[84:85] op_sel_hi:[1,0,1]
    v_pk_fma_f32 v[86:87], v[54:55], v[90:91], v[86:87] op_sel_hi:[1,0,1]
    s_waitcnt lgkmcnt(3)
    v_and_b32 v90, 0xffff0000, v11
    v_lshlrev_b32 v48, 16, v44
    v_and_b32 v49, 0xffff0000, v44
    v_lshlrev_b32 v50, 16, v45
    v_and_b32 v51, 0xffff0000, v45
    v_lshlrev_b32 v52, 16, v46
    v_and_b32 v53, 0xffff0000, v46
    v_lshlrev_b32 v54, 16, v47
    v_and_b32 v55, 0xffff0000, v47
    ds_read_b128 v[44:47], v9 offset:11264
    v_pk_fma_f32 v[80:81], v[48:49], v[90:91], v[80:81] op_sel_hi:[1,0,1]
    v_pk_fma_f32 v[82:83], v[50:51], v[90:91], v[82:83] op_sel_hi:[1,0,1]
    v_pk_fma_f32 v[84:85], v[52:53], v[90:91], v[84:85] op_sel_hi:[1,0,1]
    v_pk_fma_f32 v[86:87], v[54:55], v[90:91], v[86:87] op_sel_hi:[1,0,1]
    s_waitcnt lgkmcnt(3)
    v_lshlrev_b32 v90, 16, v12
    v_lshlrev_b32 v48, 16, v32
    v_and_b32 v49, 0xffff0000, v32
    v_lshlrev_b32 v50, 16, v33
    v_and_b32 v51, 0xffff0000, v33
    v_lshlrev_b32 v52, 16, v34
    v_and_b32 v53, 0xffff0000, v34
    v_lshlrev_b32 v54, 16, v35
    v_and_b32 v55, 0xffff0000, v35
    ds_read_b128 v[32:35], v9 offset:12288
    v_pk_fma_f32 v[80:81], v[48:49], v[90:91], v[80:81] op_sel_hi:[1,0,1]
    v_pk_fma_f32 v[82:83], v[50:51], v[90:91], v[82:83] op_sel_hi:[1,0,1]
    v_pk_fma_f32 v[84:85], v[52:53], v[90:91], v[84:85] op_sel_hi:[1,0,1]
    v_pk_fma_f32 v[86:87], v[54:55], v[90:91], v[86:87] op_sel_hi:[1,0,1]
    s_waitcnt lgkmcnt(3)
    v_and_b32 v90, 0xffff0000, v12
    v_lshlrev_b32 v48, 16, v36
    v_and_b32 v49, 0xffff0000, v36
    v_lshlrev_b32 v50, 16, v37
    v_and_b32 v51, 0xffff0000, v37
    v_lshlrev_b32 v52, 16, v38
    v_and_b32 v53, 0xffff0000, v38
    v_lshlrev_b32 v54, 16, v39
    v_and_b32 v55, 0xffff0000, v39
    ds_read_b128 v[36:39], v9 offset:13312
    v_pk_fma_f32 v[80:81], v[48:49], v[90:91], v[80:81] op_sel_hi:[1,0,1]
    v_pk_fma_f32 v[82:83], v[50:51], v[90:91], v[82:83] op_sel_hi:[1,0,1]
    v_pk_fma_f32 v[84:85], v[52:53], v[90:91], v[84:85] op_sel_hi:[1,0,1]
    v_pk_fma_f32 v[86:87], v[54:55], v[90:91], v[86:87] op_sel_hi:[1,0,1]
    s_waitcnt lgkmcnt(3)
    v_lshlrev_b32 v90, 16, v13
    v_lshlrev_b32 v48, 16, v40
    v_and_b32 v49, 0xffff0000, v40
    v_lshlrev_b32 v50, 16, v41
    v_and_b32 v51, 0xffff0000, v41
    v_lshlrev_b32 v52, 16, v42
    v_and_b32 v53, 0xffff0000, v42
    v_lshlrev_b32 v54, 16, v43
    v_and_b32 v55, 0xffff0000, v43
    ds_read_b128 v[40:43], v9 offset:14336
    v_pk_fma_f32 v[80:81], v[48:49], v[90:91], v[80:81] op_sel_hi:[1,0,1]
    v_pk_fma_f32 v[82:83], v[50:51], v[90:91], v[82:83] op_sel_hi:[1,0,1]
    v_pk_fma_f32 v[84:85], v[52:53], v[90:91], v[84:85] op_sel_hi:[1,0,1]
    v_pk_fma_f32 v[86:87], v[54:55], v[90:91], v[86:87] op_sel_hi:[1,0,1]
    s_waitcnt lgkmcnt(3)
    v_and_b32 v90, 0xffff0000, v13
    v_lshlrev_b32 v48, 16, v44
    v_and_b32 v49, 0xffff0000, v44
    v_lshlrev_b32 v50, 16, v45
    v_and_b32 v51, 0xffff0000, v45
    v_lshlrev_b32 v52, 16, v46
    v_and_b32 v53, 0xffff0000, v46
    v_lshlrev_b32 v54, 16, v47
    v_and_b32 v55, 0xffff0000, v47
    ds_read_b128 v[44:47], v9 offset:15360
    v_pk_fma_f32 v[80:81], v[48:49], v[90:91], v[80:81] op_sel_hi:[1,0,1]
    v_pk_fma_f32 v[82:83], v[50:51], v[90:91], v[82:83] op_sel_hi:[1,0,1]
    v_pk_fma_f32 v[84:85], v[52:53], v[90:91], v[84:85] op_sel_hi:[1,0,1]
    v_pk_fma_f32 v[86:87], v[54:55], v[90:91], v[86:87] op_sel_hi:[1,0,1]
    s_waitcnt lgkmcnt(3)
    v_lshlrev_b32 v90, 16, v14
    v_lshlrev_b32 v48, 16, v32
    v_and_b32 v49, 0xffff0000, v32
    v_lshlrev_b32 v50, 16, v33
    v_and_b32 v51, 0xffff0000, v33
    v_lshlrev_b32 v52, 16, v34
    v_and_b32 v53, 0xffff0000, v34
    v_lshlrev_b32 v54, 16, v35
    v_and_b32 v55, 0xffff0000, v35
    ds_read_b128 v[32:35], v9 offset:16384
    v_pk_fma_f32 v[80:81], v[48:49], v[90:91], v[80:81] op_sel_hi:[1,0,1]
    v_pk_fma_f32 v[82:83], v[50:51], v[90:91], v[82:83] op_sel_hi:[1,0,1]
    v_pk_fma_f32 v[84:85], v[52:53], v[90:91], v[84:85] op_sel_hi:[1,0,1]
    v_pk_fma_f32 v[86:87], v[54:55], v[90:91], v[86:87] op_sel_hi:[1,0,1]
    s_waitcnt lgkmcnt(3)
    v_and_b32 v90, 0xffff0000, v14
    v_lshlrev_b32 v48, 16, v36
    v_and_b32 v49, 0xffff0000, v36
    v_lshlrev_b32 v50, 16, v37
    v_and_b32 v51, 0xffff0000, v37
    v_lshlrev_b32 v52, 16, v38
    v_and_b32 v53, 0xffff0000, v38
    v_lshlrev_b32 v54, 16, v39
    v_and_b32 v55, 0xffff0000, v39
    ds_read_b128 v[36:39], v9 offset:17408
    v_pk_fma_f32 v[80:81], v[48:49], v[90:91], v[80:81] op_sel_hi:[1,0,1]
    v_pk_fma_f32 v[82:83], v[50:51], v[90:91], v[82:83] op_sel_hi:[1,0,1]
    v_pk_fma_f32 v[84:85], v[52:53], v[90:91], v[84:85] op_sel_hi:[1,0,1]
    v_pk_fma_f32 v[86:87], v[54:55], v[90:91], v[86:87] op_sel_hi:[1,0,1]
    s_waitcnt lgkmcnt(3)
    v_lshlrev_b32 v90, 16, v15
    v_lshlrev_b32 v48, 16, v40
    v_and_b32 v49, 0xffff0000, v40
    v_lshlrev_b32 v50, 16, v41
    v_and_b32 v51, 0xffff0000, v41
    v_lshlrev_b32 v52, 16, v42
    v_and_b32 v53, 0xffff0000, v42
    v_lshlrev_b32 v54, 16, v43
    v_and_b32 v55, 0xffff0000, v43
    ds_read_b128 v[40:43], v9 offset:18432
    v_pk_fma_f32 v[80:81], v[48:49], v[90:91], v[80:81] op_sel_hi:[1,0,1]
    v_pk_fma_f32 v[82:83], v[50:51], v[90:91], v[82:83] op_sel_hi:[1,0,1]
    v_pk_fma_f32 v[84:85], v[52:53], v[90:91], v[84:85] op_sel_hi:[1,0,1]
    v_pk_fma_f32 v[86:87], v[54:55], v[90:91], v[86:87] op_sel_hi:[1,0,1]
    s_waitcnt lgkmcnt(3)
    v_and_b32 v90, 0xffff0000, v15
    v_lshlrev_b32 v48, 16, v44
    v_and_b32 v49, 0xffff0000, v44
    v_lshlrev_b32 v50, 16, v45
    v_and_b32 v51, 0xffff0000, v45
    v_lshlrev_b32 v52, 16, v46
    v_and_b32 v53, 0xffff0000, v46
    v_lshlrev_b32 v54, 16, v47
    v_and_b32 v55, 0xffff0000, v47
    ds_read_b128 v[44:47], v9 offset:19456
    v_pk_fma_f32 v[80:81], v[48:49], v[90:91], v[80:81] op_sel_hi:[1,0,1]
    v_pk_fma_f32 v[82:83], v[50:51], v[90:91], v[82:83] op_sel_hi:[1,0,1]
    v_pk_fma_f32 v[84:85], v[52:53], v[90:91], v[84:85] op_sel_hi:[1,0,1]
    v_pk_fma_f32 v[86:87], v[54:55], v[90:91], v[86:87] op_sel_hi:[1,0,1]
    s_waitcnt lgkmcnt(3)
    v_lshlrev_b32 v90, 16, v16
    v_lshlrev_b32 v48, 16, v32
    v_and_b32 v49, 0xffff0000, v32
    v_lshlrev_b32 v50, 16, v33
    v_and_b32 v51, 0xffff0000, v33
    v_lshlrev_b32 v52, 16, v34
    v_and_b32 v53, 0xffff0000, v34
    v_lshlrev_b32 v54, 16, v35
    v_and_b32 v55, 0xffff0000, v35
    ds_read_b128 v[32:35], v9 offset:20480
    v_pk_fma_f32 v[80:81], v[48:49], v[90:91], v[80:81] op_sel_hi:[1,0,1]
    v_pk_fma_f32 v[82:83], v[50:51], v[90:91], v[82:83] op_sel_hi:[1,0,1]
    v_pk_fma_f32 v[84:85], v[52:53], v[90:91], v[84:85] op_sel_hi:[1,0,1]
    v_pk_fma_f32 v[86:87], v[54:55], v[90:91], v[86:87] op_sel_hi:[1,0,1]
    s_waitcnt lgkmcnt(3)
    v_and_b32 v90, 0xffff0000, v16
    v_lshlrev_b32 v48, 16, v36
    v_and_b32 v49, 0xffff0000, v36
    v_lshlrev_b32 v50, 16, v37
    v_and_b32 v51, 0xffff0000, v37
    v_lshlrev_b32 v52, 16, v38
    v_and_b32 v53, 0xffff0000, v38
    v_lshlrev_b32 v54, 16, v39
    v_and_b32 v55, 0xffff0000, v39
    ds_read_b128 v[36:39], v9 offset:21504
    v_pk_fma_f32 v[80:81], v[48:49], v[90:91], v[80:81] op_sel_hi:[1,0,1]
    v_pk_fma_f32 v[82:83], v[50:51], v[90:91], v[82:83] op_sel_hi:[1,0,1]
    v_pk_fma_f32 v[84:85], v[52:53], v[90:91], v[84:85] op_sel_hi:[1,0,1]
    v_pk_fma_f32 v[86:87], v[54:55], v[90:91], v[86:87] op_sel_hi:[1,0,1]
    s_waitcnt lgkmcnt(3)
    v_lshlrev_b32 v90, 16, v17
    v_lshlrev_b32 v48, 16, v40
    v_and_b32 v49, 0xffff0000, v40
    v_lshlrev_b32 v50, 16, v41
    v_and_b32 v51, 0xffff0000, v41
    v_lshlrev_b32 v52, 16, v42
    v_and_b32 v53, 0xffff0000, v42
    v_lshlrev_b32 v54, 16, v43
    v_and_b32 v55, 0xffff0000, v43
    ds_read_b128 v[40:43], v9 offset:22528
    v_pk_fma_f32 v[80:81], v[48:49], v[90:91], v[80:81] op_sel_hi:[1,0,1]
    v_pk_fma_f32 v[82:83], v[50:51], v[90:91], v[82:83] op_sel_hi:[1,0,1]
    v_pk_fma_f32 v[84:85], v[52:53], v[90:91], v[84:85] op_sel_hi:[1,0,1]
    v_pk_fma_f32 v[86:87], v[54:55], v[90:91], v[86:87] op_sel_hi:[1,0,1]
    s_waitcnt lgkmcnt(3)
    v_and_b32 v90, 0xffff0000, v17
    v_lshlrev_b32 v48, 16, v44
    v_and_b32 v49, 0xffff0000, v44
    v_lshlrev_b32 v50, 16, v45
    v_and_b32 v51, 0xffff0000, v45
    v_lshlrev_b32 v52, 16, v46
    v_and_b32 v53, 0xffff0000, v46
    v_lshlrev_b32 v54, 16, v47
    v_and_b32 v55, 0xffff0000, v47
    ds_read_b128 v[44:47], v9 offset:23552
    v_pk_fma_f32 v[80:81], v[48:49], v[90:91], v[80:81] op_sel_hi:[1,0,1]
    v_pk_fma_f32 v[82:83], v[50:51], v[90:91], v[82:83] op_sel_hi:[1,0,1]
    v_pk_fma_f32 v[84:85], v[52:53], v[90:91], v[84:85] op_sel_hi:[1,0,1]
    v_pk_fma_f32 v[86:87], v[54:55], v[90:91], v[86:87] op_sel_hi:[1,0,1]
    s_waitcnt lgkmcnt(3)
    v_lshlrev_b32 v90, 16, v18
    v_lshlrev_b32 v48, 16, v32
    v_and_b32 v49, 0xffff0000, v32
    v_lshlrev_b32 v50, 16, v33
    v_and_b32 v51, 0xffff0000, v33
    v_lshlrev_b32 v52, 16, v34
    v_and_b32 v53, 0xffff0000, v34
    v_lshlrev_b32 v54, 16, v35
    v_and_b32 v55, 0xffff0000, v35
    ds_read_b128 v[32:35], v9 offset:24576
    v_pk_fma_f32 v[80:81], v[48:49], v[90:91], v[80:81] op_sel_hi:[1,0,1]
    v_pk_fma_f32 v[82:83], v[50:51], v[90:91], v[82:83] op_sel_hi:[1,0,1]
    v_pk_fma_f32 v[84:85], v[52:53], v[90:91], v[84:85] op_sel_hi:[1,0,1]
    v_pk_fma_f32 v[86:87], v[54:55], v[90:91], v[86:87] op_sel_hi:[1,0,1]
    s_waitcnt lgkmcnt(3)
    v_and_b32 v90, 0xffff0000, v18
    v_lshlrev_b32 v48, 16, v36
    v_and_b32 v49, 0xffff0000, v36
    v_lshlrev_b32 v50, 16, v37
    v_and_b32 v51, 0xffff0000, v37
    v_lshlrev_b32 v52, 16, v38
    v_and_b32 v53, 0xffff0000, v38
    v_lshlrev_b32 v54, 16, v39
    v_and_b32 v55, 0xffff0000, v39
    ds_read_b128 v[36:39], v9 offset:25600
    v_pk_fma_f32 v[80:81], v[48:49], v[90:91], v[80:81] op_sel_hi:[1,0,1]
    v_pk_fma_f32 v[82:83], v[50:51], v[90:91], v[82:83] op_sel_hi:[1,0,1]
    v_pk_fma_f32 v[84:85], v[52:53], v[90:91], v[84:85] op_sel_hi:[1,0,1]
    v_pk_fma_f32 v[86:87], v[54:55], v[90:91], v[86:87] op_sel_hi:[1,0,1]
    s_waitcnt lgkmcnt(3)
    v_lshlrev_b32 v90, 16, v19
    v_lshlrev_b32 v48, 16, v40
    v_and_b32 v49, 0xffff0000, v40
    v_lshlrev_b32 v50, 16, v41
    v_and_b32 v51, 0xffff0000, v41
    v_lshlrev_b32 v52, 16, v42
    v_and_b32 v53, 0xffff0000, v42
    v_lshlrev_b32 v54, 16, v43
    v_and_b32 v55, 0xffff0000, v43
    ds_read_b128 v[40:43], v9 offset:26624
    v_pk_fma_f32 v[80:81], v[48:49], v[90:91], v[80:81] op_sel_hi:[1,0,1]
    v_pk_fma_f32 v[82:83], v[50:51], v[90:91], v[82:83] op_sel_hi:[1,0,1]
    v_pk_fma_f32 v[84:85], v[52:53], v[90:91], v[84:85] op_sel_hi:[1,0,1]
    v_pk_fma_f32 v[86:87], v[54:55], v[90:91], v[86:87] op_sel_hi:[1,0,1]
    s_waitcnt lgkmcnt(3)
    v_and_b32 v90, 0xffff0000, v19
    v_lshlrev_b32 v48, 16, v44
    v_and_b32 v49, 0xffff0000, v44
    v_lshlrev_b32 v50, 16, v45
    v_and_b32 v51, 0xffff0000, v45
    v_lshlrev_b32 v52, 16, v46
    v_and_b32 v53, 0xffff0000, v46
    v_lshlrev_b32 v54, 16, v47
    v_and_b32 v55, 0xffff0000, v47
    ds_read_b128 v[44:47], v9 offset:27648
    v_pk_fma_f32 v[80:81], v[48:49], v[90:91], v[80:81] op_sel_hi:[1,0,1]
    v_pk_fma_f32 v[82:83], v[50:51], v[90:91], v[82:83] op_sel_hi:[1,0,1]
    v_pk_fma_f32 v[84:85], v[52:53], v[90:91], v[84:85] op_sel_hi:[1,0,1]
    v_pk_fma_f32 v[86:87], v[54:55], v[90:91], v[86:87] op_sel_hi:[1,0,1]
    s_waitcnt lgkmcnt(3)
    v_lshlrev_b32 v90, 16, v20
    v_lshlrev_b32 v48, 16, v32
    v_and_b32 v49, 0xffff0000, v32
    v_lshlrev_b32 v50, 16, v33
    v_and_b32 v51, 0xffff0000, v33
    v_lshlrev_b32 v52, 16, v34
    v_and_b32 v53, 0xffff0000, v34
    v_lshlrev_b32 v54, 16, v35
    v_and_b32 v55, 0xffff0000, v35
    ds_read_b128 v[32:35], v9 offset:28672
    v_pk_fma_f32 v[80:81], v[48:49], v[90:91], v[80:81] op_sel_hi:[1,0,1]
    v_pk_fma_f32 v[82:83], v[50:51], v[90:91], v[82:83] op_sel_hi:[1,0,1]
    v_pk_fma_f32 v[84:85], v[52:53], v[90:91], v[84:85] op_sel_hi:[1,0,1]
    v_pk_fma_f32 v[86:87], v[54:55], v[90:91], v[86:87] op_sel_hi:[1,0,1]
    s_waitcnt lgkmcnt(3)
    v_and_b32 v90, 0xffff0000, v20
    v_lshlrev_b32 v48, 16, v36
    v_and_b32 v49, 0xffff0000, v36
    v_lshlrev_b32 v50, 16, v37
    v_and_b32 v51, 0xffff0000, v37
    v_lshlrev_b32 v52, 16, v38
    v_and_b32 v53, 0xffff0000, v38
    v_lshlrev_b32 v54, 16, v39
    v_and_b32 v55, 0xffff0000, v39
    ds_read_b128 v[36:39], v9 offset:29696
    v_pk_fma_f32 v[80:81], v[48:49], v[90:91], v[80:81] op_sel_hi:[1,0,1]
    v_pk_fma_f32 v[82:83], v[50:51], v[90:91], v[82:83] op_sel_hi:[1,0,1]
    v_pk_fma_f32 v[84:85], v[52:53], v[90:91], v[84:85] op_sel_hi:[1,0,1]
    v_pk_fma_f32 v[86:87], v[54:55], v[90:91], v[86:87] op_sel_hi:[1,0,1]
    s_waitcnt lgkmcnt(3)
    v_lshlrev_b32 v90, 16, v21
    v_lshlrev_b32 v48, 16, v40
    v_and_b32 v49, 0xffff0000, v40
    v_lshlrev_b32 v50, 16, v41
    v_and_b32 v51, 0xffff0000, v41
    v_lshlrev_b32 v52, 16, v42
    v_and_b32 v53, 0xffff0000, v42
    v_lshlrev_b32 v54, 16, v43
    v_and_b32 v55, 0xffff0000, v43
    ds_read_b128 v[40:43], v9 offset:30720
    v_pk_fma_f32 v[80:81], v[48:49], v[90:91], v[80:81] op_sel_hi:[1,0,1]
    v_pk_fma_f32 v[82:83], v[50:51], v[90:91], v[82:83] op_sel_hi:[1,0,1]
    v_pk_fma_f32 v[84:85], v[52:53], v[90:91], v[84:85] op_sel_hi:[1,0,1]
    v_pk_fma_f32 v[86:87], v[54:55], v[90:91], v[86:87] op_sel_hi:[1,0,1]
    s_waitcnt lgkmcnt(3)
    v_and_b32 v90, 0xffff0000, v21
    v_lshlrev_b32 v48, 16, v44
    v_and_b32 v49, 0xffff0000, v44
    v_lshlrev_b32 v50, 16, v45
    v_and_b32 v51, 0xffff0000, v45
    v_lshlrev_b32 v52, 16, v46
    v_and_b32 v53, 0xffff0000, v46
    v_lshlrev_b32 v54, 16, v47
    v_and_b32 v55, 0xffff0000, v47
    ds_read_b128 v[44:47], v9 offset:31744
    v_pk_fma_f32 v[80:81], v[48:49], v[90:91], v[80:81] op_sel_hi:[1,0,1]
    v_pk_fma_f32 v[82:83], v[50:51], v[90:91], v[82:83] op_sel_hi:[1,0,1]
    v_pk_fma_f32 v[84:85], v[52:53], v[90:91], v[84:85] op_sel_hi:[1,0,1]
    v_pk_fma_f32 v[86:87], v[54:55], v[90:91], v[86:87] op_sel_hi:[1,0,1]
    s_waitcnt lgkmcnt(3)
    v_lshlrev_b32 v90, 16, v22
    v_lshlrev_b32 v48, 16, v32
    v_and_b32 v49, 0xffff0000, v32
    v_lshlrev_b32 v50, 16, v33
    v_and_b32 v51, 0xffff0000, v33
    v_lshlrev_b32 v52, 16, v34
    v_and_b32 v53, 0xffff0000, v34
    v_lshlrev_b32 v54, 16, v35
    v_and_b32 v55, 0xffff0000, v35
    v_pk_fma_f32 v[80:81], v[48:49], v[90:91], v[80:81] op_sel_hi:[1,0,1]
    v_pk_fma_f32 v[82:83], v[50:51], v[90:91], v[82:83] op_sel_hi:[1,0,1]
    v_pk_fma_f32 v[84:85], v[52:53], v[90:91], v[84:85] op_sel_hi:[1,0,1]
    v_pk_fma_f32 v[86:87], v[54:55], v[90:91], v[86:87] op_sel_hi:[1,0,1]
    s_waitcnt lgkmcnt(2)
    v_and_b32 v90, 0xffff0000, v22
    v_lshlrev_b32 v48, 16, v36
    v_and_b32 v49, 0xffff0000, v36
    v_lshlrev_b32 v50, 16, v37
    v_and_b32 v51, 0xffff0000, v37
    v_lshlrev_b32 v52, 16, v38
    v_and_b32 v53, 0xffff0000, v38
    v_lshlrev_b32 v54, 16, v39
    v_and_b32 v55, 0xffff0000, v39
    v_pk_fma_f32 v[80:81], v[48:49], v[90:91], v[80:81] op_sel_hi:[1,0,1]
    v_pk_fma_f32 v[82:83], v[50:51], v[90:91], v[82:83] op_sel_hi:[1,0,1]
    v_pk_fma_f32 v[84:85], v[52:53], v[90:91], v[84:85] op_sel_hi:[1,0,1]
    v_pk_fma_f32 v[86:87], v[54:55], v[90:91], v[86:87] op_sel_hi:[1,0,1]
    s_waitcnt lgkmcnt(1)
    v_lshlrev_b32 v90, 16, v23
    v_lshlrev_b32 v48, 16, v40
    v_and_b32 v49, 0xffff0000, v40
    v_lshlrev_b32 v50, 16, v41
    v_and_b32 v51, 0xffff0000, v41
    v_lshlrev_b32 v52, 16, v42
    v_and_b32 v53, 0xffff0000, v42
    v_lshlrev_b32 v54, 16, v43
    v_and_b32 v55, 0xffff0000, v43
    v_pk_fma_f32 v[80:81], v[48:49], v[90:91], v[80:81] op_sel_hi:[1,0,1]
    v_pk_fma_f32 v[82:83], v[50:51], v[90:91], v[82:83] op_sel_hi:[1,0,1]
    v_pk_fma_f32 v[84:85], v[52:53], v[90:91], v[84:85] op_sel_hi:[1,0,1]
    v_pk_fma_f32 v[86:87], v[54:55], v[90:91], v[86:87] op_sel_hi:[1,0,1]
    s_waitcnt lgkmcnt(0)
    v_and_b32 v90, 0xffff0000, v23
    v_lshlrev_b32 v48, 16, v44
    v_and_b32 v49, 0xffff0000, v44
    v_lshlrev_b32 v50, 16, v45
    v_and_b32 v51, 0xffff0000, v45
    v_lshlrev_b32 v52, 16, v46
    v_and_b32 v53, 0xffff0000, v46
    v_lshlrev_b32 v54, 16, v47
    v_and_b32 v55, 0xffff0000, v47
    v_pk_fma_f32 v[80:81], v[48:49], v[90:91], v[80:81] op_sel_hi:[1,0,1]
    v_pk_fma_f32 v[82:83], v[50:51], v[90:91], v[82:83] op_sel_hi:[1,0,1]
    v_pk_fma_f32 v[84:85], v[52:53], v[90:91], v[84:85] op_sel_hi:[1,0,1]
    v_pk_fma_f32 v[86:87], v[54:55], v[90:91], v[86:87] op_sel_hi:[1,0,1]
    v_lshlrev_b32 v3, 7, v1
    v_lshl_add_u32 v3, v2, 5, v3
    ds_write_b128 v3, v[80:83] offset:2048
    ds_write_b128 v3, v[84:87] offset:2064
    v_and_b32 v4, 15, v0
    v_lshlrev_b32 v5, 3, v4
    s_waitcnt lgkmcnt(0)
    ds_read_b64 v[32:33], v5 offset:2048
    ds_read_b64 v[34:35], v5 offset:2176
    ds_read_b64 v[36:37], v5 offset:2304
    ds_read_b64 v[38:39], v5 offset:2432
    ds_read_b64 v[40:41], v5 offset:2560
    ds_read_b64 v[42:43], v5 offset:2688
    ds_read_b64 v[44:45], v5 offset:2816
    ds_read_b64 v[46:47], v5 offset:2944
    ds_read_b64 v[48:49], v5 offset:3072
    ds_read_b64 v[50:51], v5 offset:3200
    ds_read_b64 v[52:53], v5 offset:3328
    ds_read_b64 v[54:55], v5 offset:3456
    ds_read_b64 v[56:57], v5 offset:3584
    ds_read_b64 v[58:59], v5 offset:3712
    ds_read_b64 v[60:61], v5 offset:3840
    ds_read_b64 v[62:63], v5 offset:3968
    s_waitcnt lgkmcnt(0)
    v_pk_add_f32 v[32:33], v[32:33], v[48:49]
    v_pk_add_f32 v[34:35], v[34:35], v[50:51]
    v_pk_add_f32 v[36:37], v[36:37], v[52:53]
    v_pk_add_f32 v[38:39], v[38:39], v[54:55]
    v_pk_add_f32 v[40:41], v[40:41], v[56:57]
    v_pk_add_f32 v[42:43], v[42:43], v[58:59]
    v_pk_add_f32 v[44:45], v[44:45], v[60:61]
    v_pk_add_f32 v[46:47], v[46:47], v[62:63]
    v_pk_add_f32 v[32:33], v[32:33], v[40:41]
    v_pk_add_f32 v[34:35], v[34:35], v[42:43]
    v_pk_add_f32 v[36:37], v[36:37], v[44:45]
    v_pk_add_f32 v[38:39], v[38:39], v[46:47]
    v_pk_add_f32 v[32:33], v[32:33], v[36:37]
    v_pk_add_f32 v[34:35], v[34:35], v[38:39]
    v_pk_add_f32 v[32:33], v[32:33], v[34:35]
    v_cvt_pk_bf16_f32 v64, v32, v33
    v_mov_b32 v65, 0
    v_mov_b32 v66, s94
    v_mov_b32 v67, s95
    s_lshl_b32 s46, s2, 8
    s_mov_b32 exec_lo, 0xffff
    s_mov_b32 exec_hi, 0
    buffer_store_dwordx4 v[64:67], v9, s[12:15], s46 offen sc1
    s_mov_b64 exec, -1
    s_lshl_b32 s52, s101, 12
    s_mov_b32 s53, 0
L_QPOLL:
    s_nop 4
    buffer_load_dwordx4 v[32:35], v9, s[12:15], s52 offen offset:0 sc1
    buffer_load_dwordx4 v[36:39], v9, s[12:15], s52 offen offset:1024 sc1
    buffer_load_dwordx4 v[40:43], v9, s[12:15], s52 offen offset:2048 sc1
    buffer_load_dwordx4 v[44:47], v9, s[12:15], s52 offen offset:3072 sc1
    s_waitcnt vmcnt(0)
    v_xor_b32 v48, s94, v34
    v_xor_b32 v50, s95, v35
    v_or_b32 v48, v48, v50
    v_xor_b32 v49, s94, v38
    v_xor_b32 v50, s95, v39
    v_or_b32 v49, v49, v50
    v_or_b32 v48, v48, v49
    v_xor_b32 v49, s94, v42
    v_xor_b32 v50, s95, v43
    v_or_b32 v49, v49, v50
    v_or_b32 v48, v48, v49
    v_xor_b32 v49, s94, v46
    v_xor_b32 v50, s95, v47
    v_or_b32 v49, v49, v50
    v_or_b32 v48, v48, v49
    v_cmp_ne_u32 vcc, 0, v48
    s_cmp_lg_u64 vcc, 0
    s_cbranch_scc0 L_QOK
    s_add_u32 s53, s53, 1
    s_cmp_lt_u32 s53, 30000
    s_cbranch_scc0 L_QOK
    s_sleep 1
    s_branch L_QPOLL
L_QOK:
    s_nop 2
    v_lshlrev_b32 v5, 2, v0
    ds_write_b32 v5, v32 offset:0
    ds_write_b32 v5, v36 offset:256
    ds_write_b32 v5, v40 offset:512
    ds_write_b32 v5, v44 offset:768
    s_waitcnt lgkmcnt(0)
    s_barrier
    s_cmp_ge_u32 s2, 224
    s_cbranch_scc1 L_AUX_NOWO
    s_cmp_ge_u32 s2, 112
    s_cselect_b32 s44, 1, 0
    s_mul_i32 s45, s44, 112
    s_sub_u32 s45, s2, s45
    s_mul_hi_u32 s46, s45, 0x24924925
    s_mul_i32 s47, s46, 7
    s_sub_u32 s47, s45, s47
    s_cmp_eq_u32 s44, 0
    s_cselect_b32 s4, s24, s34
    s_cselect_b32 s5, s25, s35
    s_and_b32 s5, s5, 0xffff
    s_mov_b32 s6, 3670016
    s_mov_b32 s7, 0x00020000
    s_mul_i32 s52, s46, 229376
    s_lshl_b32 s53, s47, 7
    s_add_u32 s52, s52, s53
    v_lshrrev_b32 v1, 3, v0
    v_mul_u32_u24 v7, 896, v1
    v_and_b32 v2, 7, v0
    v_lshl_add_u32 v7, v2, 4, v7
    s_mov_b32 m0, 45056
    s_nop 0
    buffer_load_dwordx4 v7, s[4:7], s52 offen lds
    s_add_u32 s52, s52, 7168
    s_mov_b32 m0, 46080
    s_nop 0
    buffer_load_dwordx4 v7, s[4:7], s52 offen lds
    s_add_u32 s52, s52, 7168
    s_mov_b32 m0, 47104
    s_nop 0
    buffer_load_dwordx4 v7, s[4:7], s52 offen lds
    s_add_u32 s52, s52, 7168
    s_mov_b32 m0, 48128
    s_nop 0
    buffer_load_dwordx4 v7, s[4:7], s52 offen lds
    s_add_u32 s52, s52, 7168
    s_mov_b32 m0, 49152
    s_nop 0
    buffer_load_dwordx4 v7, s[4:7], s52 offen lds
    s_add_u32 s52, s52, 7168
    s_mov_b32 m0, 50176
    s_nop 0
    buffer_load_dwordx4 v7, s[4:7], s52 offen lds
    s_add_u32 s52, s52, 7168
    s_mov_b32 m0, 51200
    s_nop 0
    buffer_load_dwordx4 v7, s[4:7], s52 offen lds
    s_add_u32 s52, s52, 7168
    s_mov_b32 m0, 52224
    s_nop 0
    buffer_load_dwordx4 v7, s[4:7], s52 offen lds
    s_add_u32 s52, s52, 7168
    s_mov_b32 m0, 53248
    s_nop 0
    buffer_load_dwordx4 v7, s[4:7], s52 offen lds
    s_add_u32 s52, s52, 7168
    s_mov_b32 m0, 54272
    s_nop 0
    buffer_load_dwordx4 v7, s[4:7], s52 offen lds
    s_add_u32 s52, s52, 7168
    s_mov_b32 m0, 55296
    s_nop 0
    buffer_load_dwordx4 v7, s[4:7], s52 offen lds
    s_add_u32 s52, s52, 7168
    s_mov_b32 m0, 56320
    s_nop 0
    buffer_load_dwordx4 v7, s[4:7], s52 offen lds
    s_add_u32 s52, s52, 7168
    s_mov_b32 m0, 57344
    s_nop 0
    buffer_load_dwordx4 v7, s[4:7], s52 offen lds
    s_add_u32 s52, s52, 7168
    s_mov_b32 m0, 58368
    s_nop 0
    buffer_load_dwordx4 v7, s[4:7], s52 offen lds
    s_add_u32 s52, s52, 7168
    s_mov_b32 m0, 59392
    s_nop 0
    buffer_load_dwordx4 v7, s[4:7], s52 offen lds
    s_add_u32 s52, s52, 7168
    s_mov_b32 m0, 60416
    s_nop 0
    buffer_load_dwordx4 v7, s[4:7], s52 offen lds
    s_add_u32 s52, s52, 7168
    s_mov_b32 m0, 61440
    s_nop 0
    buffer_load_dwordx4 v7, s[4:7], s52 offen lds
    s_add_u32 s52, s52, 7168
    s_mov_b32 m0, 62464
    s_nop 0
    buffer_load_dwordx4 v7, s[4:7], s52 offen lds
    s_add_u32 s52, s52, 7168
    s_mov_b32 m0, 63488
    s_nop 0
    buffer_load_dwordx4 v7, s[4:7], s52 offen lds
    s_add_u32 s52, s52, 7168
    s_mov_b32 m0, 64512
    s_nop 0
    buffer_load_dwordx4 v7, s[4:7], s52 offen lds
    s_add_u32 s52, s52, 7168
    s_mov_b32 m0, 65536
    s_nop 0
    buffer_load_dwordx4 v7, s[4:7], s52 offen lds
    s_add_u32 s52, s52, 7168
    s_mov_b32 m0, 66560
    s_nop 0
    buffer_load_dwordx4 v7, s[4:7], s52 offen lds
    s_add_u32 s52, s52, 7168
    s_mov_b32 m0, 67584
    s_nop 0
    buffer_load_dwordx4 v7, s[4:7], s52 offen lds
    s_add_u32 s52, s52, 7168
    s_mov_b32 m0, 68608
    s_nop 0
    buffer_load_dwordx4 v7, s[4:7], s52 offen lds
    s_add_u32 s52, s52, 7168
    s_mov_b32 m0, 69632
    s_nop 0
    buffer_load_dwordx4 v7, s[4:7], s52 offen lds
    s_add_u32 s52, s52, 7168
    s_mov_b32 m0, 70656
    s_nop 0
    buffer_load_dwordx4 v7, s[4:7], s52 offen lds
    s_add_u32 s52, s52, 7168
    s_mov_b32 m0, 71680
    s_nop 0
    buffer_load_dwordx4 v7, s[4:7], s52 offen lds
    s_add_u32 s52, s52, 7168
    s_mov_b32 m0, 72704
    s_nop 0
    buffer_load_dwordx4 v7, s[4:7], s52 offen lds
    s_add_u32 s52, s52, 7168
    s_mov_b32 m0, 73728
    s_nop 0
    buffer_load_dwordx4 v7, s[4:7], s52 offen lds
    s_add_u32 s52, s52, 7168
    s_mov_b32 m0, 74752
    s_nop 0
    buffer_load_dwordx4 v7, s[4:7], s52 offen lds
    s_add_u32 s52, s52, 7168
    s_mov_b32 m0, 75776
    s_nop 0
    buffer_load_dwordx4 v7, s[4:7], s52 offen lds
    s_add_u32 s52, s52, 7168
    s_mov_b32 m0, 76800
    s_nop 0
    buffer_load_dwordx4 v7, s[4:7], s52 offen lds
L_AUX_NOWO:
    s_cmp_lt_u32 s2, 224
    s_cbranch_scc1 L_AUX_NOGATE
    s_cmp_ge_u32 s2, 231
    s_cbranch_scc1 L_AUX_NOGATE
    s_mov_b32 s52, s36
    s_and_b32 s53, s37, 0xffff
    s_mov_b32 s54, 896
    s_mov_b32 s55, 0x00020000
    v_lshlrev_b32 v5, 1, v0
    buffer_load_ushort v32, v5, s[48:51], 0 offen offset:0
    buffer_load_ushort v40, v5, s[52:55], 0 offen offset:0
    buffer_load_ushort v33, v5, s[48:51], 0 offen offset:128
    buffer_load_ushort v41, v5, s[52:55], 0 offen offset:128
    buffer_load_ushort v34, v5, s[48:51], 0 offen offset:256
    buffer_load_ushort v42, v5, s[52:55], 0 offen offset:256
    buffer_load_ushort v35, v5, s[48:51], 0 offen offset:384
    buffer_load_ushort v43, v5, s[52:55], 0 offen offset:384
    buffer_load_ushort v36, v5, s[48:51], 0 offen offset:512
    buffer_load_ushort v44, v5, s[52:55], 0 offen offset:512
    buffer_load_ushort v37, v5, s[48:51], 0 offen offset:640
    buffer_load_ushort v45, v5, s[52:55], 0 offen offset:640
    buffer_load_ushort v38, v5, s[48:51], 0 offen offset:768
    buffer_load_ushort v46, v5, s[52:55], 0 offen offset:768
    v_mov_b32 v48, 0
    s_waitcnt vmcnt(0)
    v_lshlrev_b32 v32, 16, v32
    v_lshlrev_b32 v40, 16, v40
    v_mul_f32 v32, v32, v40
    v_cvt_pk_bf16_f32 v49, v32, v32
    v_lshlrev_b32 v32, 16, v49
    v_add_f32 v48, v48, v32
    v_lshlrev_b32 v33, 16, v33
    v_lshlrev_b32 v41, 16, v41
    v_mul_f32 v33, v33, v41
    v_cvt_pk_bf16_f32 v49, v33, v33
    v_lshlrev_b32 v33, 16, v49
    v_add_f32 v48, v48, v33
    v_lshlrev_b32 v34, 16, v34
    v_lshlrev_b32 v42, 16, v42
    v_mul_f32 v34, v34, v42
    v_cvt_pk_bf16_f32 v49, v34, v34
    v_lshlrev_b32 v34, 16, v49
    v_add_f32 v48, v48, v34
    v_lshlrev_b32 v35, 16, v35
    v_lshlrev_b32 v43, 16, v43
    v_mul_f32 v35, v35, v43
    v_cvt_pk_bf16_f32 v49, v35, v35
    v_lshlrev_b32 v35, 16, v49
    v_add_f32 v48, v48, v35
    v_lshlrev_b32 v36, 16, v36
    v_lshlrev_b32 v44, 16, v44
    v_mul_f32 v36, v36, v44
    v_cvt_pk_bf16_f32 v49, v36, v36
    v_lshlrev_b32 v36, 16, v49
    v_add_f32 v48, v48, v36
    v_lshlrev_b32 v37, 16, v37
    v_lshlrev_b32 v45, 16, v45
    v_mul_f32 v37, v37, v45
    v_cvt_pk_bf16_f32 v49, v37, v37
    v_lshlrev_b32 v37, 16, v49
    v_add_f32 v48, v48, v37
    v_lshlrev_b32 v38, 16, v38
    v_lshlrev_b32 v46, 16, v46
    v_mul_f32 v38, v38, v46
    v_cvt_pk_bf16_f32 v49, v38, v38
    v_lshlrev_b32 v38, 16, v49
    v_add_f32 v48, v48, v38
    s_nop 1
    v_add_f32_dpp v48, v48, v48 quad_perm:[1,0,3,2] row_mask:0xf bank_mask:0xf
    s_nop 1
    v_add_f32_dpp v48, v48, v48 quad_perm:[2,3,0,1] row_mask:0xf bank_mask:0xf
    s_nop 1
    v_add_f32_dpp v48, v48, v48 row_ror:4 row_mask:0xf bank_mask:0xf
    s_nop 1
    v_add_f32_dpp v48, v48, v48 row_ror:8 row_mask:0xf bank_mask:0xf
    v_mov_b32 v49, v48
    s_nop 1
    v_permlane16_swap_b32 v48, v49
    v_add_f32 v48, v48, v49
    v_mov_b32 v49, v48
    s_nop 1
    v_permlane32_swap_b32 v48, v49
    v_add_f32 v48, v48, v49
    v_cvt_pk_bf16_f32 v49, v48, v48
    v_lshlrev_b32 v48, 16, v49
    v_mul_f32 v48, 0x3fb8aa3b, v48
    v_sub_f32 v48, 0, v48
    v_exp_f32 v48, v48
    s_nop 0
    v_add_f32 v48, 1.0, v48
    v_rcp_f32 v48, v48
    s_nop 0
    v_cvt_pk_bf16_f32 v49, v48, v48
    v_lshlrev_b32 v48, 16, v49
    s_nop 0
    v_readfirstlane_b32 s93, v48
L_AUX_NOGATE:
    s_waitcnt vmcnt(0)
    s_barrier
L_TAIL:
    s_cmp_ge_u32 s3, 4
    s_cbranch_scc1 L_NOCOMB
    s_lshr_b32 s44, s3, 1
    s_and_b32 s45, s3, 1
    v_min_u32 v1, 14, v0
    v_lshlrev_b32 v1, 4, v1
    s_lshl_b32 s46, s44, 3
    v_add_u32 v1, s46, v1
    ds_read_b64 v[2:3], v1 offset:1280
    s_lshl_b32 s46, s45, 9
    s_lshl_b32 s47, s44, 10
    s_add_u32 s46, s46, s47
    v_lshlrev_b32 v7, 3, v0
    v_add_u32 v7, s46, v7
    ds_read_b64 v[16:17], v7 offset:4096
    ds_read_b64 v[18:19], v7 offset:6144
    ds_read_b64 v[20:21], v7 offset:8192
    ds_read_b64 v[22:23], v7 offset:10240
    ds_read_b64 v[24:25], v7 offset:12288
    ds_read_b64 v[26:27], v7 offset:14336
    ds_read_b64 v[28:29], v7 offset:16384
    ds_read_b64 v[30:31], v7 offset:18432
    ds_read_b64 v[32:33], v7 offset:20480
    ds_read_b64 v[34:35], v7 offset:22528
    ds_read_b64 v[36:37], v7 offset:24576
    ds_read_b64 v[38:39], v7 offset:26624
    ds_read_b64 v[40:41], v7 offset:28672
    ds_read_b64 v[42:43], v7 offset:30720
    ds_read_b64 v[44:45], v7 offset:32768
    s_waitcnt lgkmcnt(15)
    v_cmp_gt_u32 vcc, 15, v0
    v_mov_b32 v4, v2
    s_nop 1
    v_max_f32_dpp v4, v4, v4 quad_perm:[1,0,3,2] row_mask:0xf bank_mask:0xf
    s_nop 1
    v_max_f32_dpp v4, v4, v4 quad_perm:[2,3,0,1] row_mask:0xf bank_mask:0xf
    s_nop 1
    v_max_f32_dpp v4, v4, v4 row_ror:4 row_mask:0xf bank_mask:0xf
    s_nop 1
    v_max_f32_dpp v4, v4, v4 row_ror:8 row_mask:0xf bank_mask:0xf
    v_mov_b32 v5, v4
    s_nop 1
    v_permlane16_swap_b32 v4, v5
    v_max_f32 v4, v4, v5
    v_mov_b32 v5, v4
    s_nop 1
    v_permlane32_swap_b32 v4, v5
    v_max_f32 v4, v4, v5
    v_sub_f32 v5, v2, v4
    v_mul_f32 v5, 0x3fb8aa3b, v5
    v_exp_f32 v5, v5
    s_nop 0
    v_cndmask_b32 v5, 0, v5, vcc
    v_mul_f32 v6, v5, v3
    s_nop 1
    v_add_f32_dpp v6, v6, v6 quad_perm:[1,0,3,2] row_mask:0xf bank_mask:0xf
    s_nop 1
    v_add_f32_dpp v6, v6, v6 quad_perm:[2,3,0,1] row_mask:0xf bank_mask:0xf
    s_nop 1
    v_add_f32_dpp v6, v6, v6 row_ror:4 row_mask:0xf bank_mask:0xf
    s_nop 1
    v_add_f32_dpp v6, v6, v6 row_ror:8 row_mask:0xf bank_mask:0xf
    v_mov_b32 v12, v6
    s_nop 1
    v_permlane16_swap_b32 v6, v12
    v_add_f32 v6, v6, v12
    v_mov_b32 v12, v6
    s_nop 1
    v_permlane32_swap_b32 v6, v12
    v_add_f32 v6, v6, v12
    v_readlane_b32 s48, v5, 0
    v_readlane_b32 s49, v5, 1
    v_readlane_b32 s50, v5, 2
    v_readlane_b32 s51, v5, 3
    v_readlane_b32 s52, v5, 4
    v_readlane_b32 s53, v5, 5
    v_readlane_b32 s54, v5, 6
    v_readlane_b32 s55, v5, 7
    v_readlane_b32 s56, v5, 8
    v_readlane_b32 s57, v5, 9
    v_readlane_b32 s58, v5, 10
    v_readlane_b32 s59, v5, 11
    v_readlane_b32 s60, v5, 12
    v_readlane_b32 s61, v5, 13
    v_readlane_b32 s62, v5, 14
    s_waitcnt lgkmcnt(0)
    v_mul_f32 v8, s48, v16
    v_mul_f32 v9, s48, v17
    v_fma_f32 v8, v18, s49, v8
    v_fma_f32 v9, v19, s49, v9
    v_fma_f32 v8, v20, s50, v8
    v_fma_f32 v9, v21, s50, v9
    v_fma_f32 v8, v22, s51, v8
    v_fma_f32 v9, v23, s51, v9
    v_fma_f32 v8, v24, s52, v8
    v_fma_f32 v9, v25, s52, v9
    v_fma_f32 v8, v26, s53, v8
    v_fma_f32 v9, v27, s53, v9
    v_fma_f32 v8, v28, s54, v8
    v_fma_f32 v9, v29, s54, v9
    v_fma_f32 v8, v30, s55, v8
    v_fma_f32 v9, v31, s55, v9
    v_fma_f32 v8, v32, s56, v8
    v_fma_f32 v9, v33, s56, v9
    v_fma_f32 v8, v34, s57, v8
    v_fma_f32 v9, v35, s57, v9
    v_fma_f32 v8, v36, s58, v8
    v_fma_f32 v9, v37, s58, v9
    v_fma_f32 v8, v38, s59, v8
    v_fma_f32 v9, v39, s59, v9
    v_fma_f32 v8, v40, s60, v8
    v_fma_f32 v9, v41, s60, v9
    v_fma_f32 v8, v42, s61, v8
    v_fma_f32 v9, v43, s61, v9
    v_fma_f32 v8, v44, s62, v8
    v_fma_f32 v9, v45, s62, v9
    v_mov_b32 v10, s94
    v_mov_b32 v11, s95
    v_lshlrev_b32 v13, 4, v0
    s_lshl_b32 s47, s2, 13
    s_add_u32 s47, s47, 1048576
    s_lshl_b32 s46, s44, 11
    s_add_u32 s52, s47, s46
    s_lshl_b32 s46, s45, 10
    s_add_u32 s52, s52, s46
    buffer_store_dwordx4 v[8:11], v13, s[12:15], s52 offen sc1
    s_cmp_lg_u32 s45, 0
    s_cbranch_scc1 L_NOCOMB
    v_mov_b32 v16, v4
    v_mov_b32 v17, v6
    v_mov_b32 v18, s94
    v_mov_b32 v19, s95
    s_lshl_b32 s46, s44, 4
    s_add_u32 s52, s47, s46
    s_add_u32 s52, s52, 4096
    s_mov_b64 exec, 1
    buffer_store_dwordx4 v[16:19], v13, s[12:15], s52 offen sc1
    s_mov_b64 exec, -1
L_NOCOMB:
    s_cmp_lt_u32 s2, 224
    s_cbranch_scc1 L_TASK
    s_cmp_lt_u32 s2, 231
    s_cbranch_scc1 L_RED
    s_branch L_END
L_TASK:
    s_cmp_ge_u32 s2, 112
    s_cselect_b32 s44, 1, 0
    s_mul_i32 s45, s44, 112
    s_sub_u32 s45, s2, s45
    s_mul_hi_u32 s46, s45, 0x24924925
    s_mul_i32 s47, s46, 7
    s_sub_u32 s47, s45, s47
    s_lshr_b32 s52, s46, 1
    s_and_b32 s53, s46, 1
    s_lshl_b32 s54, s52, 3
    s_mul_i32 s55, s52, 24
    s_add_u32 s55, s55, 64
    s_cmp_eq_u32 s44, 0
    s_cselect_b32 s54, s54, s55
    s_cselect_b32 s55, 8, 24
    s_lshl_b32 s56, s54, 13
    s_add_u32 s56, s56, 1048576
    s_lshl_b32 s57, s55, 13
    s_add_u32 s4, s42, s56
    s_addc_u32 s5, s43, 0
    s_and_b32 s5, s5, 0xffff
    s_mov_b32 s6, s57
    s_mov_b32 s7, 0x00020000
    v_lshrrev_b32 v1, 3, v0
    v_lshlrev_b32 v2, 13, v1
    v_and_b32 v3, 7, v0
    v_lshl_add_u32 v3, v3, 4, v2
    s_lshl_b32 s57, s53, 11
    s_lshl_b32 s58, s3, 7
    s_add_u32 s57, s57, s58
    s_lshl_b32 s58, s53, 4
    s_add_u32 s58, s58, 4096
    s_sub_i32 s59, s55, 0
    v_cmp_gt_i32 s[60:61], s59, v1
    s_sub_i32 s59, s55, 8
    v_cmp_gt_i32 s[62:63], s59, v1
    s_sub_i32 s59, s55, 16
    v_cmp_gt_i32 s[64:65], s59, v1
    s_sub_i32 s59, s55, 24
    v_cmp_gt_i32 s[66:67], s59, v1
    s_mov_b32 s59, 0
L_TPOLL:
    s_add_u32 s68, s58, 0
    s_nop 3
    buffer_load_dwordx4 v[12:15], v2, s[4:7], s68 offen sc1
    s_add_u32 s68, s58, 65536
    buffer_load_dwordx4 v[20:23], v2, s[4:7], s68 offen sc1
    s_add_u32 s68, s58, 131072
    buffer_load_dwordx4 v[28:31], v2, s[4:7], s68 offen sc1
    s_add_u32 s68, s58, 196608
    buffer_load_dwordx4 v[36:39], v2, s[4:7], s68 offen sc1
    s_mov_b64 s[70:71], 0
    s_waitcnt vmcnt(0)
    v_xor_b32 v44, s94, v14
    v_xor_b32 v45, s95, v15
    v_or_b32 v44, v44, v45
    v_cmp_ne_u32 vcc, 0, v44
    s_and_b64 s[72:73], vcc, s[60:61]
    s_or_b64 s[70:71], s[70:71], s[72:73]
    v_xor_b32 v44, s94, v22
    v_xor_b32 v45, s95, v23
    v_or_b32 v44, v44, v45
    v_cmp_ne_u32 vcc, 0, v44
    s_and_b64 s[72:73], vcc, s[62:63]
    s_or_b64 s[70:71], s[70:71], s[72:73]
    v_xor_b32 v44, s94, v30
    v_xor_b32 v45, s95, v31
    v_or_b32 v44, v44, v45
    v_cmp_ne_u32 vcc, 0, v44
    s_and_b64 s[72:73], vcc, s[64:65]
    s_or_b64 s[70:71], s[70:71], s[72:73]
    v_xor_b32 v44, s94, v38
    v_xor_b32 v45, s95, v39
    v_or_b32 v44, v44, v45
    v_cmp_ne_u32 vcc, 0, v44
    s_and_b64 s[72:73], vcc, s[66:67]
    s_or_b64 s[70:71], s[70:71], s[72:73]
    s_cmp_lg_u64 s[70:71], 0
    s_cbranch_scc0 L_TML_OK
    s_add_u32 s59, s59, 1
    s_cmp_lt_u32 s59, 30000
    s_cbranch_scc0 L_TML_OK
    s_sleep 1
    s_branch L_TPOLL
L_TML_OK:
    s_add_u32 s68, s57, 0
    s_nop 3
    buffer_load_dwordx4 v[8:11], v3, s[4:7], s68 offen sc1
    s_add_u32 s68, s57, 65536
    buffer_load_dwordx4 v[16:19], v3, s[4:7], s68 offen sc1
    s_add_u32 s68, s57, 131072
    buffer_load_dwordx4 v[24:27], v3, s[4:7], s68 offen sc1
    s_add_u32 s68, s57, 196608
    buffer_load_dwordx4 v[32:35], v3, s[4:7], s68 offen sc1
    s_mov_b64 s[70:71], 0
    s_waitcnt vmcnt(0)
    v_xor_b32 v44, s94, v10
    v_xor_b32 v45, s95, v11
    v_or_b32 v44, v44, v45
    v_cmp_ne_u32 vcc, 0, v44
    s_and_b64 s[72:73], vcc, s[60:61]
    s_or_b64 s[70:71], s[70:71], s[72:73]
    v_xor_b32 v44, s94, v18
    v_xor_b32 v45, s95, v19
    v_or_b32 v44, v44, v45
    v_cmp_ne_u32 vcc, 0, v44
    s_and_b64 s[72:73], vcc, s[62:63]
    s_or_b64 s[70:71], s[70:71], s[72:73]
    v_xor_b32 v44, s94, v26
    v_xor_b32 v45, s95, v27
    v_or_b32 v44, v44, v45
    v_cmp_ne_u32 vcc, 0, v44
    s_and_b64 s[72:73], vcc, s[64:65]
    s_or_b64 s[70:71], s[70:71], s[72:73]
    v_xor_b32 v44, s94, v34
    v_xor_b32 v45, s95, v35
    v_or_b32 v44, v44, v45
    v_cmp_ne_u32 vcc, 0, v44
    s_and_b64 s[72:73], vcc, s[66:67]
    s_or_b64 s[70:71], s[70:71], s[72:73]
    s_cmp_lg_u64 s[70:71], 0
    s_cbranch_scc0 L_TOK
    s_add_u32 s59, s59, 1
    s_cmp_lt_u32 s59, 30000
    s_cbranch_scc0 L_TOK
    s_sleep 1
    s_branch L_TPOLL
L_TOK:
    s_nop 2
    v_mov_b32 v44, 0xff800000
    v_cndmask_b32 v12, v44, v12, s[60:61]
    v_cndmask_b32 v20, v44, v20, s[62:63]
    v_cndmask_b32 v28, v44, v28, s[64:65]
    v_cndmask_b32 v36, v44, v36, s[66:67]
    v_max3_f32 v45, v12, v20, v28
    v_max_f32 v45, v45, v36
    s_nop 1
    v_max_f32_dpp v45, v45, v45 row_ror:8 row_mask:0xf bank_mask:0xf
    v_mov_b32 v46, v45
    s_nop 1
    v_permlane16_swap_b32 v45, v46
    v_max_f32 v45, v45, v46
    v_mov_b32 v46, v45
    s_nop 1
    v_permlane32_swap_b32 v45, v46
    v_max_f32 v45, v45, v46
    v_sub_f32 v46, v12, v45
    v_mul_f32 v46, 0x3fb8aa3b, v46
    v_exp_f32 v46, v46
    v_sub_f32 v47, v20, v45
    v_mul_f32 v47, 0x3fb8aa3b, v47
    v_exp_f32 v47, v47
    v_sub_f32 v48, v28, v45
    v_mul_f32 v48, 0x3fb8aa3b, v48
    v_exp_f32 v48, v48
    v_sub_f32 v49, v36, v45
    v_mul_f32 v49, 0x3fb8aa3b, v49
    v_exp_f32 v49, v49
    v_mul_f32 v50, v46, v8
    v_mul_f32 v51, v46, v9
    v_mul_f32 v52, v46, v13
    v_fma_f32 v50, v47, v16, v50
    v_fma_f32 v51, v47, v17, v51
    v_fma_f32 v52, v47, v21, v52
    v_fma_f32 v50, v48, v24, v50
    v_fma_f32 v51, v48, v25, v51
    v_fma_f32 v52, v48, v29, v52
    v_fma_f32 v50, v49, v32, v50
    v_fma_f32 v51, v49, v33, v51
    v_fma_f32 v52, v49, v37, v52
    v_add_f32_dpp v50, v50, v50 row_ror:8 row_mask:0xf bank_mask:0xf
    v_mov_b32 v53, v50
    s_nop 1
    v_permlane16_swap_b32 v50, v53
    v_add_f32 v50, v50, v53
    v_mov_b32 v53, v50
    s_nop 1
    v_permlane32_swap_b32 v50, v53
    v_add_f32 v50, v50, v53
    v_add_f32_dpp v51, v51, v51 row_ror:8 row_mask:0xf bank_mask:0xf
    v_mov_b32 v53, v51
    s_nop 1
    v_permlane16_swap_b32 v51, v53
    v_add_f32 v51, v51, v53
    v_mov_b32 v53, v51
    s_nop 1
    v_permlane32_swap_b32 v51, v53
    v_add_f32 v51, v51, v53
    v_add_f32_dpp v52, v52, v52 row_ror:8 row_mask:0xf bank_mask:0xf
    v_mov_b32 v53, v52
    s_nop 1
    v_permlane16_swap_b32 v52, v53
    v_add_f32 v52, v52, v53
    v_mov_b32 v53, v52
    s_nop 1
    v_permlane32_swap_b32 v52, v53
    v_add_f32 v52, v52, v53
    v_rcp_f32 v52, v52
    s_nop 0
    v_mul_f32 v50, v50, v52
    v_mul_f32 v51, v51, v52
    v_cvt_pk_bf16_f32 v53, v50, v50
    v_lshlrev_b32 v50, 16, v53
    v_cvt_pk_bf16_f32 v53, v51, v51
    v_lshlrev_b32 v51, 16, v53
    s_lshl_b32 s68, s3, 11
    v_lshlrev_b32 v54, 1, v0
    v_add_u32 v54, s68, v54
    ds_read_u16 v56, v54 offset:45056
    ds_read_u16 v57, v54 offset:45184
    ds_read_u16 v58, v54 offset:45312
    ds_read_u16 v59, v54 offset:45440
    ds_read_u16 v60, v54 offset:45568
    ds_read_u16 v61, v54 offset:45696
    ds_read_u16 v62, v54 offset:45824
    ds_read_u16 v63, v54 offset:45952
    ds_read_u16 v64, v54 offset:46080
    ds_read_u16 v65, v54 offset:46208
    ds_read_u16 v66, v54 offset:46336
    ds_read_u16 v67, v54 offset:46464
    ds_read_u16 v68, v54 offset:46592
    ds_read_u16 v69, v54 offset:46720
    ds_read_u16 v70, v54 offset:46848
    ds_read_u16 v71, v54 offset:46976
    v_readlane_b32 s72, v50, 0
    v_readlane_b32 s73, v51, 0
    v_readlane_b32 s74, v50, 1
    v_readlane_b32 s75, v51, 1
    v_readlane_b32 s76, v50, 2
    v_readlane_b32 s77, v51, 2
    v_readlane_b32 s78, v50, 3
    v_readlane_b32 s79, v51, 3
    v_readlane_b32 s80, v50, 4
    v_readlane_b32 s81, v51, 4
    v_readlane_b32 s82, v50, 5
    v_readlane_b32 s83, v51, 5
    v_readlane_b32 s84, v50, 6
    v_readlane_b32 s85, v51, 6
    v_readlane_b32 s86, v50, 7
    v_readlane_b32 s87, v51, 7
    v_mov_b32 v55, 0
    s_waitcnt lgkmcnt(15)
    v_lshlrev_b32 v56, 16, v56
    v_fmac_f32 v55, s72, v56
    s_waitcnt lgkmcnt(14)
    v_lshlrev_b32 v57, 16, v57
    v_fmac_f32 v55, s73, v57
    s_waitcnt lgkmcnt(13)
    v_lshlrev_b32 v58, 16, v58
    v_fmac_f32 v55, s74, v58
    s_waitcnt lgkmcnt(12)
    v_lshlrev_b32 v59, 16, v59
    v_fmac_f32 v55, s75, v59
    s_waitcnt lgkmcnt(11)
    v_lshlrev_b32 v60, 16, v60
    v_fmac_f32 v55, s76, v60
    s_waitcnt lgkmcnt(10)
    v_lshlrev_b32 v61, 16, v61
    v_fmac_f32 v55, s77, v61
    s_waitcnt lgkmcnt(9)
    v_lshlrev_b32 v62, 16, v62
    v_fmac_f32 v55, s78, v62
    s_waitcnt lgkmcnt(8)
    v_lshlrev_b32 v63, 16, v63
    v_fmac_f32 v55, s79, v63
    s_waitcnt lgkmcnt(7)
    v_lshlrev_b32 v64, 16, v64
    v_fmac_f32 v55, s80, v64
    s_waitcnt lgkmcnt(6)
    v_lshlrev_b32 v65, 16, v65
    v_fmac_f32 v55, s81, v65
    s_waitcnt lgkmcnt(5)
    v_lshlrev_b32 v66, 16, v66
    v_fmac_f32 v55, s82, v66
    s_waitcnt lgkmcnt(4)
    v_lshlrev_b32 v67, 16, v67
    v_fmac_f32 v55, s83, v67
    s_waitcnt lgkmcnt(3)
    v_lshlrev_b32 v68, 16, v68
    v_fmac_f32 v55, s84, v68
    s_waitcnt lgkmcnt(2)
    v_lshlrev_b32 v69, 16, v69
    v_fmac_f32 v55, s85, v69
    s_waitcnt lgkmcnt(1)
    v_lshlrev_b32 v70, 16, v70
    v_fmac_f32 v55, s86, v70
    s_waitcnt lgkmcnt(0)
    v_lshlrev_b32 v71, 16, v71
    v_fmac_f32 v55, s87, v71
    s_lshl_b32 s68, s3, 8
    v_lshlrev_b32 v54, 2, v0
    v_add_u32 v53, s68, v54
    ds_write_b32 v53, v55 offset:34816
    s_waitcnt lgkmcnt(0)
    s_barrier
    s_cmp_lg_u32 s3, 0
    s_cbranch_scc1 L_END
    ds_read_b32 v56, v54 offset:34816
    ds_read_b32 v57, v54 offset:35072
    ds_read_b32 v58, v54 offset:35328
    ds_read_b32 v59, v54 offset:35584
    ds_read_b32 v60, v54 offset:35840
    ds_read_b32 v61, v54 offset:36096
    ds_read_b32 v62, v54 offset:36352
    ds_read_b32 v63, v54 offset:36608
    ds_read_b32 v64, v54 offset:36864
    ds_read_b32 v65, v54 offset:37120
    ds_read_b32 v66, v54 offset:37376
    ds_read_b32 v67, v54 offset:37632
    ds_read_b32 v68, v54 offset:37888
    ds_read_b32 v69, v54 offset:38144
    ds_read_b32 v70, v54 offset:38400
    ds_read_b32 v71, v54 offset:38656
    s_waitcnt lgkmcnt(0)
    v_add_f32 v56, v56, v64
    v_add_f32 v57, v57, v65
    v_add_f32 v58, v58, v66
    v_add_f32 v59, v59, v67
    v_add_f32 v60, v60, v68
    v_add_f32 v61, v61, v69
    v_add_f32 v62, v62, v70
    v_add_f32 v63, v63, v71
    v_add_f32 v56, v56, v60
    v_add_f32 v57, v57, v61
    v_add_f32 v58, v58, v62
    v_add_f32 v59, v59, v63
    v_add_f32 v56, v56, v58
    v_add_f32 v57, v57, v59
    v_add_f32 v56, v56, v57
    v_mov_b32 v60, v56
    s_nop 0
    v_mov_b32_dpp v61, v56 quad_perm:[1,0,3,2] row_mask:0xf bank_mask:0xf
    v_mov_b32 v62, s94
    v_mov_b32 v63, s95
    v_lshlrev_b32 v54, 3, v0
    s_lshl_b32 s68, s47, 14
    s_lshl_b32 s69, s44, 4
    s_add_u32 s69, s69, s46
    s_lshl_b32 s69, s69, 9
    s_add_u32 s68, s68, s69
    s_add_u32 s68, s68, 4194304
    s_mov_b32 exec_lo, 0x55555555
    s_mov_b32 exec_hi, 0x55555555
    buffer_store_dwordx4 v[60:63], v54, s[12:15], s68 offen sc1
    s_mov_b64 exec, -1
    s_branch L_END
L_RED:
    s_sub_u32 s44, s2, 224
    s_lshl_b32 s45, s44, 14
    s_lshl_b32 s46, s3, 10
    s_add_u32 s45, s45, s46
    s_add_u32 s45, s45, 4194304
    v_lshlrev_b32 v1, 4, v0
    s_mov_b32 s47, 0
L_RPOLL:
    s_nop 4
    buffer_load_dwordx4 v[4:7], v1, s[12:15], s45 offen sc1
    s_waitcnt vmcnt(0)
    v_xor_b32 v8, s94, v6
    v_xor_b32 v9, s95, v7
    v_or_b32 v8, v8, v9
    v_cmp_ne_u32 vcc, 0, v8
    s_cmp_lg_u64 vcc, 0
    s_cbranch_scc0 L_ROK
    s_add_u32 s47, s47, 1
    s_cmp_lt_u32 s47, 30000
    s_cbranch_scc0 L_ROK
    s_sleep 1
    s_branch L_RPOLL
L_ROK:
    s_nop 2
    v_mov_b32 v8, v4
    s_nop 1
    v_permlane32_swap_b32 v4, v8
    v_add_f32 v4, v4, v8
    v_mov_b32 v8, v5
    s_nop 1
    v_permlane32_swap_b32 v5, v8
    v_add_f32 v5, v5, v8
    v_and_b32 v2, 31, v0
    v_lshlrev_b32 v2, 3, v2
    s_lshl_b32 s46, s3, 8
    v_add_u32 v3, s46, v2
    ds_write_b64 v3, v[4:5] offset:38912
    s_waitcnt lgkmcnt(0)
    s_barrier
    s_cmp_lg_u32 s3, 0
    s_cbranch_scc1 L_END
    ds_read_b64 v[8:9], v2 offset:38912
    ds_read_b64 v[10:11], v2 offset:39168
    ds_read_b64 v[12:13], v2 offset:39424
    ds_read_b64 v[14:15], v2 offset:39680
    ds_read_b64 v[16:17], v2 offset:39936
    ds_read_b64 v[18:19], v2 offset:40192
    ds_read_b64 v[20:21], v2 offset:40448
    ds_read_b64 v[22:23], v2 offset:40704
    ds_read_b64 v[24:25], v2 offset:40960
    ds_read_b64 v[26:27], v2 offset:41216
    ds_read_b64 v[28:29], v2 offset:41472
    ds_read_b64 v[30:31], v2 offset:41728
    ds_read_b64 v[32:33], v2 offset:41984
    ds_read_b64 v[34:35], v2 offset:42240
    ds_read_b64 v[36:37], v2 offset:42496
    ds_read_b64 v[38:39], v2 offset:42752
    s_waitcnt lgkmcnt(0)
    v_pk_add_f32 v[8:9], v[8:9], v[16:17]
    v_pk_add_f32 v[10:11], v[10:11], v[18:19]
    v_pk_add_f32 v[12:13], v[12:13], v[20:21]
    v_pk_add_f32 v[14:15], v[14:15], v[22:23]
    v_pk_add_f32 v[8:9], v[8:9], v[12:13]
    v_pk_add_f32 v[10:11], v[10:11], v[14:15]
    v_pk_add_f32 v[8:9], v[8:9], v[10:11]
    v_pk_add_f32 v[24:25], v[24:25], v[32:33]
    v_pk_add_f32 v[26:27], v[26:27], v[34:35]
    v_pk_add_f32 v[28:29], v[28:29], v[36:37]
    v_pk_add_f32 v[30:31], v[30:31], v[38:39]
    v_pk_add_f32 v[24:25], v[24:25], v[28:29]
    v_pk_add_f32 v[26:27], v[26:27], v[30:31]
    v_pk_add_f32 v[24:25], v[24:25], v[26:27]
    v_mov_b32 v40, s93
    v_sub_f32 v41, 1.0, v40
    v_cvt_pk_bf16_f32 v42, v41, v41
    v_lshlrev_b32 v41, 16, v42
    v_cvt_pk_bf16_f32 v42, v8, v8
    v_lshlrev_b32 v8, 16, v42
    v_cvt_pk_bf16_f32 v42, v24, v24
    v_lshlrev_b32 v24, 16, v42
    v_mul_f32 v8, v40, v8
    v_cvt_pk_bf16_f32 v42, v8, v8
    v_lshlrev_b32 v8, 16, v42
    v_mul_f32 v24, v41, v24
    v_cvt_pk_bf16_f32 v42, v24, v24
    v_lshlrev_b32 v24, 16, v42
    v_add_f32 v8, v8, v24
    v_cvt_pk_bf16_f32 v42, v9, v9
    v_lshlrev_b32 v9, 16, v42
    v_cvt_pk_bf16_f32 v42, v25, v25
    v_lshlrev_b32 v25, 16, v42
    v_mul_f32 v9, v40, v9
    v_cvt_pk_bf16_f32 v42, v9, v9
    v_lshlrev_b32 v9, 16, v42
    v_mul_f32 v25, v41, v25
    v_cvt_pk_bf16_f32 v42, v25, v25
    v_lshlrev_b32 v25, 16, v42
    v_add_f32 v9, v9, v25
    v_cvt_pk_bf16_f32 v43, v8, v9
    s_mov_b32 s4, s38
    s_and_b32 s5, s39, 0xffff
    s_mov_b32 s6, 896
    s_mov_b32 s7, 0x00020000
    s_lshl_b32 s46, s44, 7
    v_lshlrev_b32 v3, 2, v0
    s_mov_b32 exec_lo, -1
    s_mov_b32 exec_hi, 0
    buffer_store_dword v43, v3, s[4:7], s46 offen
    s_mov_b64 exec, -1
L_END:
    s_endpgm
.section .rodata,"a"
.p2align 6
.amdhsa_kernel gated_mix__sliding_block_cached__gqa_block_cached__decode_kernel
  .amdhsa_next_free_vgpr 128
  .amdhsa_next_free_sgpr 102
  .amdhsa_accum_offset 128
  .amdhsa_group_segment_fixed_size 0
  .amdhsa_kernarg_size 112
  .amdhsa_user_sgpr_count 2
  .amdhsa_user_sgpr_kernarg_segment_ptr 1
  .amdhsa_system_sgpr_workgroup_id_x 1
.end_amdhsa_kernel
```
